```python
import torch

def _softmax(x, axis=-1):
    return torch.softmax(x, dim=axis)
def _gelu(x):
    return torch.nn.functional.gelu(x, approximate="tanh")
def _silu(x):
    return torch.nn.functional.silu(x)
def _sigmoid(x):
    return torch.sigmoid(x)
def _layernorm(x, axis=-1, eps=1e-5):
    m = x.mean(dim=axis, keepdim=True)
    v = x.var(dim=axis, keepdim=True, unbiased=False)
    return (x - m) / torch.sqrt(v + eps)
def _scatter_add(tgt, idx, src, axis=0):
    return tgt.clone().index_add_(axis, idx, src)
def _segment_sum(src, seg, n):
    out = torch.zeros((n,) + src.shape[1:], dtype=src.dtype)
    return out.index_add_(0, seg, src)
def _pad(x, pw):
    flat = tuple(v for pair in reversed(pw) for v in pair)
    return torch.nn.functional.pad(x, flat)

kernel_name = 'parallel_sum__ssm_conv_h3__mixer_s_mlp__prompt'

def setup_inputs():

    _w = (lambda a: (lambda t: t.to(torch.bfloat16) if t.is_floating_point() else t)(torch.as_tensor(a)))
    def _A_setup():
        B, S, D = 1, 2048, 512
        ks = 4
        return {
            "q": _w((lambda *s: torch.randn(*s, dtype=torch.bfloat16) * 0.05)(B, S, D)),
            "k": _w((lambda *s: torch.randn(*s, dtype=torch.bfloat16) * 0.8)(B, S, D)),
            "v": _w((lambda *s: torch.randn(*s, dtype=torch.bfloat16) * 0.8)(B, S, D)),
            "shift_k": _w((lambda *s: torch.randn(*s, dtype=torch.bfloat16) * 0.8)(D, ks) * 0.5),
            "ssm_k": _w((lambda *s: torch.randn(*s, dtype=torch.bfloat16) * 1.6)(D, S) * (1.0 / S ** 0.5)),
            "ssm_D": _w((lambda *s: torch.randn(*s, dtype=torch.bfloat16) * 0.8)(D)),
        }
    _A_in = _A_setup()

    def _B_setup():
        B, S, D, F = 1, 2048, 512, 1792
        return {
            "x":  _w((lambda *s: torch.randn(*s, dtype=torch.bfloat16) * 0.05)(B, S, D)),
            "w1": _w((lambda *s: torch.randn(*s, dtype=torch.bfloat16) * 3.2)(D, D) * (D ** -0.5)),
            "w2": _w((lambda *s: torch.randn(*s, dtype=torch.bfloat16) * 3.2)(D, D) * (D ** -0.5)),
            "w3": _w((lambda *s: torch.randn(*s, dtype=torch.bfloat16) * 3.2)(D, F) * (D ** -0.5)),
            "w4": _w((lambda *s: torch.randn(*s, dtype=torch.bfloat16) * 1.6)(F, D) * (F ** -0.5)),
        }
    _B_in = _B_setup()

    return {
        "A_q": _A_in["q"],
        "A_k": _A_in["k"],
        "A_v": _A_in["v"],
        "A_shift_k": _A_in["shift_k"],
        "A_ssm_k": _A_in["ssm_k"],
        "A_ssm_D": _A_in["ssm_D"],
        "B_x": _B_in["x"],
        "B_w1": _B_in["w1"],
        "B_w2": _B_in["w2"],
        "B_w3": _B_in["w3"],
        "B_w4": _B_in["w4"],
    }

def reference(A_q, A_k, A_v, A_shift_k, A_ssm_k, A_ssm_D, B_x, B_w1, B_w2, B_w3, B_w4):
    def _A_ref(q, k, v, shift_k, ssm_k, ssm_D):
        B, S, D = q.shape
        ks = shift_k.shape[-1]
        k_pad = _pad(k, ((0, 0), (ks - 1, 0), (0, 0)))
        k_shift = torch.zeros_like(k)
        for t in range(ks):
            k_shift = k_shift + k_pad[:, t:t + S, :] * shift_k[:, ks - 1 - t][None, None, :]
        kv = k_shift * v
        L = 2 * S
        kv_pad = _pad(kv, ((0, 0), (0, S), (0, 0)))
        kf_pad = _pad(ssm_k, ((0, 0), (0, S)))
        kv_f = (lambda x, axes=(-2,-1): torch.fft.rfft2(x.float(), dim=axes))(kv_pad[:, None, :, :], axes=(1, 2))
        kf_f = (lambda x, axes=(-2,-1): torch.fft.rfft2(x.float(), dim=axes))(kf_pad[:, None, :], axes=(1, 2))
        kf_f = (lambda x, *d: x.permute(*d))(kf_f, 1, 2, 0)
        y_f = kv_f * kf_f[None, :, :, :]
        y = (lambda x, s, axes=(-2,-1): torch.fft.irfft2(x, s=s, dim=axes).to(torch.bfloat16))(y_f, (1, L), axes=(1, 2))[:, 0, :S, :]
        y = y + kv * ssm_D[None, None, :]
        return q * y

    def _B_ref(x, w1, w2, w3, w4):
        B, S, D = x.shape
        h = _gelu(_layernorm(x, axis=-1) @ w1)
        c = D // 4
        g0 = _pad(h[:, :, 0*c:1*c], ((0, 0), (1, 0), (0, 0)))[:, :S, :]
        g1 = _pad(h[:, :, 1*c:2*c], ((0, 0), (0, 1), (0, 0)))[:, 1:, :]
        g2 = _pad(h[:, :, 2*c:3*c], ((0, 0), (2, 0), (0, 0)))[:, :S, :]
        g3 = _pad(h[:, :, 3*c:   ], ((0, 0), (0, 2), (0, 0)))[:, 2:, :]
        hs = torch.concatenate([g0, g1, g2, g3], axis=-1) @ w2
        x1 = x + hs
        h2 = _gelu(_layernorm(x1, axis=-1) @ w3) @ w4
        return x1 + h2

    x = A_q
    xn = _layernorm(x, axis=-1)
    return x + _A_ref(xn, A_k, A_v, A_shift_k, A_ssm_k, A_ssm_D) + _B_ref(xn, B_w1, B_w2, B_w3, B_w4)
```

```asm
; @launch grid=(256,1,1) block=(512,1,1) lds=163840
.amdgcn_target "amdgcn-amd-amdhsa--gfx950"
.text
.globl parallel_sum__ssm_conv_h3__mixer_s_mlp__prompt_kernel
.p2align 8
.type parallel_sum__ssm_conv_h3__mixer_s_mlp__prompt_kernel,@function
parallel_sum__ssm_conv_h3__mixer_s_mlp__prompt_kernel:
    s_cmp_ge_u32 s2, 256
    s_cbranch_scc1 L_end
    s_load_dwordx16 s[64:79], s[0:1], 0
    s_load_dwordx8 s[92:99], s[0:1], 64
    s_load_dwordx2 s[30:31], s[0:1], 96
    s_load_dwordx2 s[4:5], s[0:1], 104
    s_mov_b32 s6, 0x10000000
    s_mov_b32 s7, 0x20000
    s_mov_b32 s10, 0x200000
    s_mov_b32 s11, 0x20000
    s_mov_b32 s14, 0x200000
    s_mov_b32 s15, 0x20000
    s_mov_b32 s18, 0x200000
    s_mov_b32 s19, 0x20000
    s_mov_b32 s22, 0x1000
    s_mov_b32 s23, 0x20000
    s_mov_b32 s26, 0x200000
    s_mov_b32 s27, 0x20000
    s_mov_b32 s34, 0x80000
    s_mov_b32 s35, 0x20000
    s_mov_b32 s38, 0x80000
    s_mov_b32 s39, 0x20000
    s_mov_b32 s42, 0x1c0000
    s_mov_b32 s43, 0x20000
    s_mov_b32 s46, 0x1c0000
    s_mov_b32 s47, 0x20000
    s_mov_b32 s50, 0x200000
    s_mov_b32 s51, 0x20000
    s_and_b32 s100, s2, 7
    s_lshr_b32 s101, s2, 3
    s_lshr_b32 s52, s101, 3
    s_lshl_b32 s53, s100, 2
    s_add_u32 s52, s52, s53
    s_and_b32 s53, s101, 7
    s_lshr_b32 s58, s101, 4
    s_lshl_b32 s100, s100, 1
    s_add_u32 s58, s58, s100
    s_and_b32 s59, s101, 15
    v_and_b32 v22, 0xff, v0
    v_lshrrev_b32 v26, 6, v0
    v_and_b32 v0, 63, v0
    v_readfirstlane_b32 s86, v26
    v_lshlrev_b32 v1, 4, v0
    v_lshrrev_b32 v23, 5, v0
    v_and_b32 v24, 31, v0
    s_and_b32 s54, s86, 3
    s_lshr_b32 s55, s54, 1
    s_and_b32 s56, s54, 1
    s_lshl_b32 s60, s52, 1
    s_add_u32 s60, s60, s55
    s_lshl_b32 s61, s58, 2
    s_add_u32 s61, s61, s54
    s_mov_b32 s80, 0x3f803f80
    s_mov_b32 s81, 0xffff0000
    s_movk_i32 s82, 0x1000
    s_movk_i32 s83, 0x2000
    s_movk_i32 s84, 0x3000
    s_mov_b32 s85, 0x3727c5ac
    s_mov_b32 s87, 0xc0135761
    s_mov_b32 s88, 0xbdd2d3e8
    s_mov_b32 s89, 0x3b000000
    s_waitcnt lgkmcnt(0)
    s_mov_b64 s[8:9], s[64:65]
    s_mov_b64 s[32:33], s[78:79]
    s_mov_b64 s[12:13], s[66:67]
    s_mov_b64 s[16:17], s[68:69]
    s_mov_b64 s[20:21], s[70:71]
    s_mov_b64 s[24:25], s[72:73]
    s_mov_b64 s[28:29], s[74:75]
    s_mov_b64 s[36:37], s[92:93]
    s_mov_b64 s[40:41], s[94:95]
    s_mov_b64 s[44:45], s[96:97]
    s_mov_b64 s[48:49], s[98:99]
    s_add_u32 s92, s52, s53
    s_and_b32 s92, s92, 3
    s_cmp_ge_u32 s86, 4
    s_cbranch_scc1 L_loader
    s_setprio 1
    s_lshl_b32 s64, s2, 2
    s_load_dword s62, s[28:29], s64
    v_mov_b32 v26, 0
    buffer_load_dword v30, v26, s[4:7], 0 offen sc1
    s_lshr_b32 s68, s2, 3
    s_lshl_b32 s68, s68, 2
    s_add_u32 s68, s68, s54
    s_lshl_b32 s69, s68, 2
    v_add_u32 v26, s69, v0
    v_lshlrev_b32 v26, 10, v26
    v_add_u32 v26, 384, v26
    v_mov_b32 v27, 0x40000000
    v_cmp_gt_u32 vcc, 4, v0
    s_nop 1
    v_cndmask_b32 v26, v27, v26, vcc
    buffer_load_dword v160, v26, s[32:35], 0 offen
    s_and_b32 s69, s2, 7
    s_lshl_b32 s69, s69, 7
    s_add_u32 s69, s69, s68
    s_lshl_b32 s69, s69, 1
    v_add_u32 v26, s69, v0
    v_lshlrev_b32 v26, 10, v26
    v_add_u32 v26, 384, v26
    v_mov_b32 v27, 0x40000000
    v_cmp_gt_u32 vcc, 2, v0
    s_nop 1
    v_cndmask_b32 v26, v27, v26, vcc
    buffer_load_dword v161, v26, s[12:15], 0 offen
    v_add_u32 v26, s69, v0
    v_lshlrev_b32 v26, 10, v26
    v_add_u32 v26, 384, v26
    v_mov_b32 v27, 0x40000000
    v_cmp_gt_u32 vcc, 2, v0
    s_nop 1
    v_cndmask_b32 v26, v27, v26, vcc
    buffer_load_dword v162, v26, s[16:19], 0 offen
    v_mov_b32 v27, 0x40000000
    v_mul_u32_u24 v26, 16383, v0
    v_lshlrev_b32 v26, 7, v26
    v_cmp_gt_u32 vcc, 2, v0
    s_nop 1
    v_cndmask_b32 v26, v27, v26, vcc
    buffer_load_dword v166, v26, s[24:27], 0 offen
    v_mul_u32_u24 v26, 14335, v0
    v_lshlrev_b32 v26, 7, v26
    v_cmp_gt_u32 vcc, 2, v0
    s_nop 1
    v_cndmask_b32 v26, v27, v26, vcc
    buffer_load_dword v167, v26, s[40:43], 0 offen
    v_mul_u32_u24 v26, 14335, v0
    v_lshlrev_b32 v26, 7, v26
    v_cmp_gt_u32 vcc, 2, v0
    s_nop 1
    v_cndmask_b32 v26, v27, v26, vcc
    buffer_load_dword v168, v26, s[44:47], 0 offen
    v_mul_u32_u24 v26, 4095, v0
    v_lshlrev_b32 v26, 7, v26
    v_cmp_gt_u32 vcc, 2, v0
    s_nop 1
    v_cndmask_b32 v26, v27, v26, vcc
    buffer_load_dword v169, v26, s[36:39], 0 offen
    s_lshr_b32 s68, s2, 3
    s_lshl_b32 s68, s68, 2
    s_add_u32 s68, s68, s54
    v_bfe_u32 v26, v0, 2, 2
    v_and_b32 v27, 3, v0
    v_bfe_u32 v28, v0, 4, 1
    v_lshlrev_b32 v27, 3, v27
    v_lshl_add_u32 v27, v28, 5, v27
    v_lshl_add_u32 v28, v23, 2, v26
    v_lshl_add_u32 v2, v28, 6, v27
    v_lshl_add_u32 v28, v23, 3, v26
    v_lshl_add_u32 v3, v28, 6, v27
    v_bfe_u32 v26, v24, 1, 3
    v_xor_b32 v26, v26, v23
    v_lshlrev_b32 v26, 4, v26
    v_lshl_add_u32 v26, v24, 7, v26
    s_lshl_b32 s64, s54, 14
    v_add_u32 v128, s64, v26
    v_xor_b32 v129, 32, v128
    v_xor_b32 v130, 64, v128
    v_xor_b32 v131, 96, v128
    s_lshl_b32 s64, s56, 14
    s_add_u32 s64, s64, 65536
    s_lshl_b32 s65, s56, 15
    s_add_u32 s68, s64, s65
    v_add_u32 v134, s68, v3
    s_xor_b32 s65, s65, 0x8000
    s_add_u32 s68, s64, s65
    v_add_u32 v135, s68, v3
    s_xor_b32 s65, s56, s55
    s_lshl_b32 s65, s65, 15
    s_add_u32 s68, s64, s65
    v_add_u32 v136, s68, v3
    v_lshrrev_b32 v26, 4, v0
    v_xor_b32 v26, v26, v0
    v_and_b32 v26, 1, v26
    v_mov_b32 v27, s80
    v_cmp_eq_u32 vcc, 0, v26
    s_nop 1
    v_cndmask_b32 v124, 0, v27, vcc
    v_mov_b32 v125, v124
    v_mov_b32 v126, v124
    v_mov_b32 v127, v124
    v_mov_b32 v120, 0
    v_mov_b32 v121, 0
    v_mov_b32 v122, 0
    v_mov_b32 v123, 0
    s_barrier
    ds_read_b128 v[80:83], v128 offset:0
    ds_read_b128 v[84:87], v129 offset:0
    ds_read_b128 v[88:91], v130 offset:0
    ds_read_b128 v[92:95], v131 offset:0
    ds_read_b64_tr_b16 v[96:97], v134 offset:0
    ds_read_b64_tr_b16 v[98:99], v134 offset:256
    ds_read_b64_tr_b16 v[104:105], v135 offset:0
    ds_read_b64_tr_b16 v[106:107], v135 offset:256
    ds_read_b64_tr_b16 v[112:113], v136 offset:0
    ds_read_b64_tr_b16 v[114:115], v136 offset:256
    s_waitcnt lgkmcnt(6)
    v_dot2c_f32_bf16 v120, s80, v80
    v_dot2c_f32_bf16 v122, v80, v80
    v_dot2c_f32_bf16 v121, s80, v81
    v_dot2c_f32_bf16 v123, v81, v81
    v_dot2c_f32_bf16 v120, s80, v82
    v_dot2c_f32_bf16 v122, v82, v82
    v_dot2c_f32_bf16 v121, s80, v83
    v_dot2c_f32_bf16 v123, v83, v83
    v_dot2c_f32_bf16 v120, s80, v84
    v_dot2c_f32_bf16 v122, v84, v84
    v_dot2c_f32_bf16 v121, s80, v85
    v_dot2c_f32_bf16 v123, v85, v85
    v_dot2c_f32_bf16 v120, s80, v86
    v_dot2c_f32_bf16 v122, v86, v86
    v_dot2c_f32_bf16 v121, s80, v87
    v_dot2c_f32_bf16 v123, v87, v87
    v_dot2c_f32_bf16 v120, s80, v88
    v_dot2c_f32_bf16 v122, v88, v88
    v_dot2c_f32_bf16 v121, s80, v89
    v_dot2c_f32_bf16 v123, v89, v89
    v_dot2c_f32_bf16 v120, s80, v90
    v_dot2c_f32_bf16 v122, v90, v90
    v_dot2c_f32_bf16 v121, s80, v91
    v_dot2c_f32_bf16 v123, v91, v91
    v_dot2c_f32_bf16 v120, s80, v92
    v_dot2c_f32_bf16 v122, v92, v92
    v_dot2c_f32_bf16 v121, s80, v93
    v_dot2c_f32_bf16 v123, v93, v93
    v_dot2c_f32_bf16 v120, s80, v94
    v_dot2c_f32_bf16 v122, v94, v94
    v_dot2c_f32_bf16 v121, s80, v95
    v_dot2c_f32_bf16 v123, v95, v95
    s_waitcnt lgkmcnt(4)
    v_mfma_f32_32x32x16_bf16 v[32:47], v[96:99], v[80:83], 0
    ds_read_b64_tr_b16 v[100:101], v134 offset:1024
    ds_read_b64_tr_b16 v[102:103], v134 offset:1280
    s_waitcnt lgkmcnt(4)
    v_mfma_f32_32x32x16_bf16 v[48:63], v[104:107], v[80:83], 0
    ds_read_b64_tr_b16 v[108:109], v135 offset:1024
    ds_read_b64_tr_b16 v[110:111], v135 offset:1280
    s_waitcnt lgkmcnt(4)
    v_mfma_f32_16x16x32_bf16 v[64:67], v[112:115], v[124:127], 0
    ds_read_b64_tr_b16 v[116:117], v136 offset:1024
    ds_read_b64_tr_b16 v[118:119], v136 offset:1280
    s_waitcnt lgkmcnt(4)
    v_mfma_f32_32x32x16_bf16 v[32:47], v[100:103], v[84:87], v[32:47]
    ds_read_b64_tr_b16 v[96:97], v134 offset:2048
    ds_read_b64_tr_b16 v[98:99], v134 offset:2304
    s_waitcnt lgkmcnt(4)
    v_mfma_f32_32x32x16_bf16 v[48:63], v[108:111], v[84:87], v[48:63]
    ds_read_b64_tr_b16 v[104:105], v135 offset:2048
    ds_read_b64_tr_b16 v[106:107], v135 offset:2304
    s_waitcnt lgkmcnt(4)
    v_mfma_f32_16x16x32_bf16 v[64:67], v[116:119], v[124:127], v[64:67]
    ds_read_b64_tr_b16 v[112:113], v136 offset:2048
    ds_read_b64_tr_b16 v[114:115], v136 offset:2304
    s_waitcnt lgkmcnt(4)
    v_mfma_f32_32x32x16_bf16 v[32:47], v[96:99], v[88:91], v[32:47]
    ds_read_b64_tr_b16 v[100:101], v134 offset:3072
    ds_read_b64_tr_b16 v[102:103], v134 offset:3328
    s_waitcnt lgkmcnt(4)
    v_mfma_f32_32x32x16_bf16 v[48:63], v[104:107], v[88:91], v[48:63]
    ds_read_b64_tr_b16 v[108:109], v135 offset:3072
    ds_read_b64_tr_b16 v[110:111], v135 offset:3328
    s_waitcnt lgkmcnt(4)
    v_mfma_f32_16x16x32_bf16 v[64:67], v[112:115], v[124:127], v[64:67]
    ds_read_b64_tr_b16 v[116:117], v136 offset:3072
    ds_read_b64_tr_b16 v[118:119], v136 offset:3328
    s_waitcnt lgkmcnt(4)
    v_mfma_f32_32x32x16_bf16 v[32:47], v[100:103], v[92:95], v[32:47]
    s_waitcnt lgkmcnt(2)
    v_mfma_f32_32x32x16_bf16 v[48:63], v[108:111], v[92:95], v[48:63]
    s_waitcnt lgkmcnt(0)
    v_mfma_f32_16x16x32_bf16 v[64:67], v[116:119], v[124:127], v[64:67]
    s_barrier
    ds_read_b128 v[80:83], v128 offset:4096
    ds_read_b128 v[84:87], v129 offset:4096
    ds_read_b128 v[88:91], v130 offset:4096
    ds_read_b128 v[92:95], v131 offset:4096
    ds_read_b64_tr_b16 v[96:97], v134 offset:4096
    ds_read_b64_tr_b16 v[98:99], v134 offset:4352
    ds_read_b64_tr_b16 v[104:105], v135 offset:4096
    ds_read_b64_tr_b16 v[106:107], v135 offset:4352
    ds_read_b64_tr_b16 v[112:113], v136 offset:4096
    ds_read_b64_tr_b16 v[114:115], v136 offset:4352
    s_waitcnt lgkmcnt(6)
    v_dot2c_f32_bf16 v120, s80, v80
    v_dot2c_f32_bf16 v122, v80, v80
    v_dot2c_f32_bf16 v121, s80, v81
    v_dot2c_f32_bf16 v123, v81, v81
    v_dot2c_f32_bf16 v120, s80, v82
    v_dot2c_f32_bf16 v122, v82, v82
    v_dot2c_f32_bf16 v121, s80, v83
    v_dot2c_f32_bf16 v123, v83, v83
    v_dot2c_f32_bf16 v120, s80, v84
    v_dot2c_f32_bf16 v122, v84, v84
    v_dot2c_f32_bf16 v121, s80, v85
    v_dot2c_f32_bf16 v123, v85, v85
    v_dot2c_f32_bf16 v120, s80, v86
    v_dot2c_f32_bf16 v122, v86, v86
    v_dot2c_f32_bf16 v121, s80, v87
    v_dot2c_f32_bf16 v123, v87, v87
    v_dot2c_f32_bf16 v120, s80, v88
    v_dot2c_f32_bf16 v122, v88, v88
    v_dot2c_f32_bf16 v121, s80, v89
    v_dot2c_f32_bf16 v123, v89, v89
    v_dot2c_f32_bf16 v120, s80, v90
    v_dot2c_f32_bf16 v122, v90, v90
    v_dot2c_f32_bf16 v121, s80, v91
    v_dot2c_f32_bf16 v123, v91, v91
    v_dot2c_f32_bf16 v120, s80, v92
    v_dot2c_f32_bf16 v122, v92, v92
    v_dot2c_f32_bf16 v121, s80, v93
    v_dot2c_f32_bf16 v123, v93, v93
    v_dot2c_f32_bf16 v120, s80, v94
    v_dot2c_f32_bf16 v122, v94, v94
    v_dot2c_f32_bf16 v121, s80, v95
    v_dot2c_f32_bf16 v123, v95, v95
    s_waitcnt lgkmcnt(4)
    v_mfma_f32_32x32x16_bf16 v[32:47], v[96:99], v[80:83], v[32:47]
    ds_read_b64_tr_b16 v[100:101], v134 offset:5120
    ds_read_b64_tr_b16 v[102:103], v134 offset:5376
    s_waitcnt lgkmcnt(4)
    v_mfma_f32_32x32x16_bf16 v[48:63], v[104:107], v[80:83], v[48:63]
    ds_read_b64_tr_b16 v[108:109], v135 offset:5120
    ds_read_b64_tr_b16 v[110:111], v135 offset:5376
    s_waitcnt lgkmcnt(4)
    v_mfma_f32_16x16x32_bf16 v[64:67], v[112:115], v[124:127], v[64:67]
    ds_read_b64_tr_b16 v[116:117], v136 offset:5120
    ds_read_b64_tr_b16 v[118:119], v136 offset:5376
    s_waitcnt lgkmcnt(4)
    v_mfma_f32_32x32x16_bf16 v[32:47], v[100:103], v[84:87], v[32:47]
    ds_read_b64_tr_b16 v[96:97], v134 offset:6144
    ds_read_b64_tr_b16 v[98:99], v134 offset:6400
    s_waitcnt lgkmcnt(4)
    v_mfma_f32_32x32x16_bf16 v[48:63], v[108:111], v[84:87], v[48:63]
    ds_read_b64_tr_b16 v[104:105], v135 offset:6144
    ds_read_b64_tr_b16 v[106:107], v135 offset:6400
    s_waitcnt lgkmcnt(4)
    v_mfma_f32_16x16x32_bf16 v[64:67], v[116:119], v[124:127], v[64:67]
    ds_read_b64_tr_b16 v[112:113], v136 offset:6144
    ds_read_b64_tr_b16 v[114:115], v136 offset:6400
    s_waitcnt lgkmcnt(4)
    v_mfma_f32_32x32x16_bf16 v[32:47], v[96:99], v[88:91], v[32:47]
    ds_read_b64_tr_b16 v[100:101], v134 offset:7168
    ds_read_b64_tr_b16 v[102:103], v134 offset:7424
    s_waitcnt lgkmcnt(4)
    v_mfma_f32_32x32x16_bf16 v[48:63], v[104:107], v[88:91], v[48:63]
    ds_read_b64_tr_b16 v[108:109], v135 offset:7168
    ds_read_b64_tr_b16 v[110:111], v135 offset:7424
    s_waitcnt lgkmcnt(4)
    v_mfma_f32_16x16x32_bf16 v[64:67], v[112:115], v[124:127], v[64:67]
    ds_read_b64_tr_b16 v[116:117], v136 offset:7168
    ds_read_b64_tr_b16 v[118:119], v136 offset:7424
    s_waitcnt lgkmcnt(4)
    v_mfma_f32_32x32x16_bf16 v[32:47], v[100:103], v[92:95], v[32:47]
    s_waitcnt lgkmcnt(2)
    v_mfma_f32_32x32x16_bf16 v[48:63], v[108:111], v[92:95], v[48:63]
    s_waitcnt lgkmcnt(0)
    v_mfma_f32_16x16x32_bf16 v[64:67], v[116:119], v[124:127], v[64:67]
    s_barrier
    ds_read_b128 v[80:83], v128 offset:8192
    ds_read_b128 v[84:87], v129 offset:8192
    ds_read_b128 v[88:91], v130 offset:8192
    ds_read_b128 v[92:95], v131 offset:8192
    ds_read_b64_tr_b16 v[96:97], v134 offset:8192
    ds_read_b64_tr_b16 v[98:99], v134 offset:8448
    ds_read_b64_tr_b16 v[104:105], v135 offset:8192
    ds_read_b64_tr_b16 v[106:107], v135 offset:8448
    ds_read_b64_tr_b16 v[112:113], v136 offset:8192
    ds_read_b64_tr_b16 v[114:115], v136 offset:8448
    s_waitcnt lgkmcnt(6)
    v_dot2c_f32_bf16 v120, s80, v80
    v_dot2c_f32_bf16 v122, v80, v80
    v_dot2c_f32_bf16 v121, s80, v81
    v_dot2c_f32_bf16 v123, v81, v81
    v_dot2c_f32_bf16 v120, s80, v82
    v_dot2c_f32_bf16 v122, v82, v82
    v_dot2c_f32_bf16 v121, s80, v83
    v_dot2c_f32_bf16 v123, v83, v83
    v_dot2c_f32_bf16 v120, s80, v84
    v_dot2c_f32_bf16 v122, v84, v84
    v_dot2c_f32_bf16 v121, s80, v85
    v_dot2c_f32_bf16 v123, v85, v85
    v_dot2c_f32_bf16 v120, s80, v86
    v_dot2c_f32_bf16 v122, v86, v86
    v_dot2c_f32_bf16 v121, s80, v87
    v_dot2c_f32_bf16 v123, v87, v87
    v_dot2c_f32_bf16 v120, s80, v88
    v_dot2c_f32_bf16 v122, v88, v88
    v_dot2c_f32_bf16 v121, s80, v89
    v_dot2c_f32_bf16 v123, v89, v89
    v_dot2c_f32_bf16 v120, s80, v90
    v_dot2c_f32_bf16 v122, v90, v90
    v_dot2c_f32_bf16 v121, s80, v91
    v_dot2c_f32_bf16 v123, v91, v91
    v_dot2c_f32_bf16 v120, s80, v92
    v_dot2c_f32_bf16 v122, v92, v92
    v_dot2c_f32_bf16 v121, s80, v93
    v_dot2c_f32_bf16 v123, v93, v93
    v_dot2c_f32_bf16 v120, s80, v94
    v_dot2c_f32_bf16 v122, v94, v94
    v_dot2c_f32_bf16 v121, s80, v95
    v_dot2c_f32_bf16 v123, v95, v95
    s_waitcnt lgkmcnt(4)
    v_mfma_f32_32x32x16_bf16 v[32:47], v[96:99], v[80:83], v[32:47]
    ds_read_b64_tr_b16 v[100:101], v134 offset:9216
    ds_read_b64_tr_b16 v[102:103], v134 offset:9472
    s_waitcnt lgkmcnt(4)
    v_mfma_f32_32x32x16_bf16 v[48:63], v[104:107], v[80:83], v[48:63]
    ds_read_b64_tr_b16 v[108:109], v135 offset:9216
    ds_read_b64_tr_b16 v[110:111], v135 offset:9472
    s_waitcnt lgkmcnt(4)
    v_mfma_f32_16x16x32_bf16 v[64:67], v[112:115], v[124:127], v[64:67]
    ds_read_b64_tr_b16 v[116:117], v136 offset:9216
    ds_read_b64_tr_b16 v[118:119], v136 offset:9472
    s_waitcnt lgkmcnt(4)
    v_mfma_f32_32x32x16_bf16 v[32:47], v[100:103], v[84:87], v[32:47]
    ds_read_b64_tr_b16 v[96:97], v134 offset:10240
    ds_read_b64_tr_b16 v[98:99], v134 offset:10496
    s_waitcnt lgkmcnt(4)
    v_mfma_f32_32x32x16_bf16 v[48:63], v[108:111], v[84:87], v[48:63]
    ds_read_b64_tr_b16 v[104:105], v135 offset:10240
    ds_read_b64_tr_b16 v[106:107], v135 offset:10496
    s_waitcnt lgkmcnt(4)
    v_mfma_f32_16x16x32_bf16 v[64:67], v[116:119], v[124:127], v[64:67]
    ds_read_b64_tr_b16 v[112:113], v136 offset:10240
    ds_read_b64_tr_b16 v[114:115], v136 offset:10496
    s_waitcnt lgkmcnt(4)
    v_mfma_f32_32x32x16_bf16 v[32:47], v[96:99], v[88:91], v[32:47]
    ds_read_b64_tr_b16 v[100:101], v134 offset:11264
    ds_read_b64_tr_b16 v[102:103], v134 offset:11520
    s_waitcnt lgkmcnt(4)
    v_mfma_f32_32x32x16_bf16 v[48:63], v[104:107], v[88:91], v[48:63]
    ds_read_b64_tr_b16 v[108:109], v135 offset:11264
    ds_read_b64_tr_b16 v[110:111], v135 offset:11520
    s_waitcnt lgkmcnt(4)
    v_mfma_f32_16x16x32_bf16 v[64:67], v[112:115], v[124:127], v[64:67]
    ds_read_b64_tr_b16 v[116:117], v136 offset:11264
    ds_read_b64_tr_b16 v[118:119], v136 offset:11520
    s_waitcnt lgkmcnt(4)
    v_mfma_f32_32x32x16_bf16 v[32:47], v[100:103], v[92:95], v[32:47]
    s_waitcnt lgkmcnt(2)
    v_mfma_f32_32x32x16_bf16 v[48:63], v[108:111], v[92:95], v[48:63]
    s_waitcnt lgkmcnt(0)
    v_mfma_f32_16x16x32_bf16 v[64:67], v[116:119], v[124:127], v[64:67]
    ds_read_b128 v[80:83], v128 offset:12288
    ds_read_b128 v[84:87], v129 offset:12288
    ds_read_b128 v[88:91], v130 offset:12288
    ds_read_b128 v[92:95], v131 offset:12288
    ds_read_b64_tr_b16 v[96:97], v134 offset:12288
    ds_read_b64_tr_b16 v[98:99], v134 offset:12544
    ds_read_b64_tr_b16 v[104:105], v135 offset:12288
    ds_read_b64_tr_b16 v[106:107], v135 offset:12544
    ds_read_b64_tr_b16 v[112:113], v136 offset:12288
    ds_read_b64_tr_b16 v[114:115], v136 offset:12544
    s_waitcnt lgkmcnt(6)
    v_dot2c_f32_bf16 v120, s80, v80
    v_dot2c_f32_bf16 v122, v80, v80
    v_dot2c_f32_bf16 v121, s80, v81
    v_dot2c_f32_bf16 v123, v81, v81
    v_dot2c_f32_bf16 v120, s80, v82
    v_dot2c_f32_bf16 v122, v82, v82
    v_dot2c_f32_bf16 v121, s80, v83
    v_dot2c_f32_bf16 v123, v83, v83
    v_dot2c_f32_bf16 v120, s80, v84
    v_dot2c_f32_bf16 v122, v84, v84
    v_dot2c_f32_bf16 v121, s80, v85
    v_dot2c_f32_bf16 v123, v85, v85
    v_dot2c_f32_bf16 v120, s80, v86
    v_dot2c_f32_bf16 v122, v86, v86
    v_dot2c_f32_bf16 v121, s80, v87
    v_dot2c_f32_bf16 v123, v87, v87
    v_dot2c_f32_bf16 v120, s80, v88
    v_dot2c_f32_bf16 v122, v88, v88
    v_dot2c_f32_bf16 v121, s80, v89
    v_dot2c_f32_bf16 v123, v89, v89
    v_dot2c_f32_bf16 v120, s80, v90
    v_dot2c_f32_bf16 v122, v90, v90
    v_dot2c_f32_bf16 v121, s80, v91
    v_dot2c_f32_bf16 v123, v91, v91
    v_dot2c_f32_bf16 v120, s80, v92
    v_dot2c_f32_bf16 v122, v92, v92
    v_dot2c_f32_bf16 v121, s80, v93
    v_dot2c_f32_bf16 v123, v93, v93
    v_dot2c_f32_bf16 v120, s80, v94
    v_dot2c_f32_bf16 v122, v94, v94
    v_dot2c_f32_bf16 v121, s80, v95
    v_dot2c_f32_bf16 v123, v95, v95
    s_waitcnt lgkmcnt(4)
    v_mfma_f32_32x32x16_bf16 v[32:47], v[96:99], v[80:83], v[32:47]
    ds_read_b64_tr_b16 v[100:101], v134 offset:13312
    ds_read_b64_tr_b16 v[102:103], v134 offset:13568
    s_waitcnt lgkmcnt(4)
    v_mfma_f32_32x32x16_bf16 v[48:63], v[104:107], v[80:83], v[48:63]
    ds_read_b64_tr_b16 v[108:109], v135 offset:13312
    ds_read_b64_tr_b16 v[110:111], v135 offset:13568
    s_waitcnt lgkmcnt(4)
    v_mfma_f32_16x16x32_bf16 v[64:67], v[112:115], v[124:127], v[64:67]
    ds_read_b64_tr_b16 v[116:117], v136 offset:13312
    ds_read_b64_tr_b16 v[118:119], v136 offset:13568
    s_waitcnt lgkmcnt(4)
    v_mfma_f32_32x32x16_bf16 v[32:47], v[100:103], v[84:87], v[32:47]
    ds_read_b64_tr_b16 v[96:97], v134 offset:14336
    ds_read_b64_tr_b16 v[98:99], v134 offset:14592
    s_waitcnt lgkmcnt(4)
    v_mfma_f32_32x32x16_bf16 v[48:63], v[108:111], v[84:87], v[48:63]
    ds_read_b64_tr_b16 v[104:105], v135 offset:14336
    ds_read_b64_tr_b16 v[106:107], v135 offset:14592
    s_waitcnt lgkmcnt(4)
    v_mfma_f32_16x16x32_bf16 v[64:67], v[116:119], v[124:127], v[64:67]
    ds_read_b64_tr_b16 v[112:113], v136 offset:14336
    ds_read_b64_tr_b16 v[114:115], v136 offset:14592
    s_waitcnt lgkmcnt(4)
    v_mfma_f32_32x32x16_bf16 v[32:47], v[96:99], v[88:91], v[32:47]
    ds_read_b64_tr_b16 v[100:101], v134 offset:15360
    ds_read_b64_tr_b16 v[102:103], v134 offset:15616
    s_waitcnt lgkmcnt(4)
    v_mfma_f32_32x32x16_bf16 v[48:63], v[104:107], v[88:91], v[48:63]
    ds_read_b64_tr_b16 v[108:109], v135 offset:15360
    ds_read_b64_tr_b16 v[110:111], v135 offset:15616
    s_waitcnt lgkmcnt(4)
    v_mfma_f32_16x16x32_bf16 v[64:67], v[112:115], v[124:127], v[64:67]
    ds_read_b64_tr_b16 v[116:117], v136 offset:15360
    ds_read_b64_tr_b16 v[118:119], v136 offset:15616
    s_waitcnt lgkmcnt(4)
    v_mfma_f32_32x32x16_bf16 v[32:47], v[100:103], v[92:95], v[32:47]
    s_waitcnt lgkmcnt(2)
    v_mfma_f32_32x32x16_bf16 v[48:63], v[108:111], v[92:95], v[48:63]
    s_waitcnt lgkmcnt(0)
    v_mfma_f32_16x16x32_bf16 v[64:67], v[116:119], v[124:127], v[64:67]
    s_lshl_b32 s68, s53, 6
    s_lshl_b32 s78, s56, 5
    s_add_u32 s68, s68, s78
    s_lshr_b32 s64, s68, 8
    s_lshl_b32 s65, s55, 1
    s_add_u32 s64, s64, s65
    s_lshl_b32 s64, s64, 14
    s_lshr_b32 s65, s68, 6
    s_sub_u32 s65, s65, s92
    s_and_b32 s65, s65, 3
    s_lshl_b32 s65, s65, 12
    s_add_u32 s64, s64, s65
    s_bfe_u32 s65, s68, 0x10005
    s_lshl_b32 s65, s65, 2
    v_bfe_u32 v26, v24, 1, 3
    v_xor_b32 v26, s65, v26
    v_lshlrev_b32 v27, 7, v24
    v_lshl_add_u32 v27, v23, 3, v27
    v_add_u32 v27, s64, v27
    v_xor_b32 v28, 0, v26
    v_lshl_add_u32 v28, v28, 4, v27
    ds_read_b64 v[4:5], v28 offset:0
    v_xor_b32 v28, 1, v26
    v_lshl_add_u32 v28, v28, 4, v27
    ds_read_b64 v[6:7], v28 offset:0
    v_xor_b32 v28, 2, v26
    v_lshl_add_u32 v28, v28, 4, v27
    ds_read_b64 v[8:9], v28 offset:0
    v_xor_b32 v28, 3, v26
    v_lshl_add_u32 v28, v28, 4, v27
    ds_read_b64 v[10:11], v28 offset:0
    v_add_f32 v120, v120, v121
    v_add_f32 v122, v122, v123
    s_nop 1
    v_permlane32_swap_b32 v120, v122
    v_add_f32 v120, v120, v122
    s_lshl_b32 s64, s54, 8
    s_add_u32 s64, s64, 155648
    v_lshl_add_u32 v27, v0, 2, s64
    ds_write_b32 v27, v120
    s_lshl_b32 s64, s54, 12
    s_add_u32 s64, s64, 139264
    v_add_u32 v26, s64, v1
    ds_write_b128 v26, v[48:51] offset:0
    ds_write_b128 v26, v[52:55] offset:1024
    ds_write_b128 v26, v[56:59] offset:2048
    ds_write_b128 v26, v[60:63] offset:3072
    s_xor_b32 s64, s56, s55
    s_lshl_b32 s64, s64, 8
    s_lshl_b32 s65, s56, 7
    s_add_u32 s64, s64, s65
    s_add_u32 s64, s64, 156672
    v_and_b32 v28, 1, v0
    v_lshlrev_b32 v28, 6, v28
    v_lshrrev_b32 v29, 4, v0
    v_lshl_add_u32 v28, v29, 4, v28
    v_add_u32 v28, s64, v28
    s_mov_b32 exec_lo, 0x30003
    s_mov_b32 exec_hi, 0x30003
    ds_write_b128 v28, v[64:67]
    s_mov_b64 exec, -1
    s_waitcnt lgkmcnt(0)
    s_and_b32 s63, s62, s81
    s_lshl_b32 s62, s62, 16
    s_barrier
    s_xor_b32 s64, s54, 1
    s_lshl_b32 s64, s64, 12
    s_add_u32 s64, s64, 139264
    v_add_u32 v26, s64, v1
    ds_read_b128 v[80:83], v26 offset:0
    ds_read_b128 v[84:87], v26 offset:1024
    ds_read_b128 v[88:91], v26 offset:2048
    ds_read_b128 v[92:95], v26 offset:3072
    s_xor_b32 s64, s54, 1
    s_lshl_b32 s64, s64, 8
    s_add_u32 s64, s64, 155648
    v_lshl_add_u32 v27, v0, 2, s64
    ds_read_b32 v121, v27
    s_lshl_b32 s64, s56, 8
    s_add_u32 s64, s64, 156672
    v_lshl_add_u32 v28, v23, 4, s64
    ds_read_b128 v[96:99], v28 offset:0
    ds_read_b128 v[128:131], v28 offset:128
    ds_read_b128 v[100:103], v28 offset:32
    ds_read_b128 v[132:135], v28 offset:160
    ds_read_b128 v[104:107], v28 offset:64
    ds_read_b128 v[136:139], v28 offset:192
    ds_read_b128 v[108:111], v28 offset:96
    ds_read_b128 v[140:143], v28 offset:224
    s_waitcnt lgkmcnt(8)
    v_add_f32 v120, v120, v121
    v_mov_b32 v122, v120
    s_nop 1
    v_permlane32_swap_b32 v120, v122
    v_mul_f32 v20, s89, v120
    v_mul_f32 v26, s89, v122
    v_fma_f32 v26, -v20, v20, v26
    v_max_f32 v26, 0, v26
    v_add_f32 v27, s85, v26
    v_rsq_f32 v21, v27
    s_nop 0
    v_mul_f32 v27, v21, v21
    v_fma_f32 v27, v27, v26, s85
    v_rsq_f32 v27, v27
    s_nop 0
    v_mul_f32 v27, v27, v21
    v_mul_f32 v112, s87, v27
    v_mul_f32 v113, v27, v27
    v_mul_f32 v113, v113, v27
    v_mul_f32 v113, s88, v113
    v_rcp_f32 v114, v27
    v_sub_f32 v116, 0, v20
    s_waitcnt lgkmcnt(0)
    v_pk_add_f32 v[96:97], v[96:97], v[128:129]
    v_pk_add_f32 v[32:33], v[32:33], v[80:81]
    v_pk_add_f32 v[98:99], v[98:99], v[130:131]
    v_pk_add_f32 v[34:35], v[34:35], v[82:83]
    v_pk_add_f32 v[100:101], v[100:101], v[132:133]
    v_pk_add_f32 v[36:37], v[36:37], v[84:85]
    v_pk_add_f32 v[102:103], v[102:103], v[134:135]
    v_pk_add_f32 v[38:39], v[38:39], v[86:87]
    v_pk_add_f32 v[104:105], v[104:105], v[136:137]
    v_pk_add_f32 v[40:41], v[40:41], v[88:89]
    v_pk_add_f32 v[106:107], v[106:107], v[138:139]
    v_pk_add_f32 v[42:43], v[42:43], v[90:91]
    v_pk_add_f32 v[108:109], v[108:109], v[140:141]
    v_pk_add_f32 v[44:45], v[44:45], v[92:93]
    v_pk_add_f32 v[110:111], v[110:111], v[142:143]
    v_pk_add_f32 v[46:47], v[46:47], v[94:95]
    v_pk_fma_f32 v[32:33], v[96:97], v[116:117], v[32:33] op_sel_hi:[1,0,1]
    v_pk_fma_f32 v[34:35], v[98:99], v[116:117], v[34:35] op_sel_hi:[1,0,1]
    v_pk_fma_f32 v[36:37], v[100:101], v[116:117], v[36:37] op_sel_hi:[1,0,1]
    v_pk_fma_f32 v[38:39], v[102:103], v[116:117], v[38:39] op_sel_hi:[1,0,1]
    v_pk_fma_f32 v[40:41], v[104:105], v[116:117], v[40:41] op_sel_hi:[1,0,1]
    v_pk_fma_f32 v[42:43], v[106:107], v[116:117], v[42:43] op_sel_hi:[1,0,1]
    v_pk_fma_f32 v[44:45], v[108:109], v[116:117], v[44:45] op_sel_hi:[1,0,1]
    v_pk_fma_f32 v[46:47], v[110:111], v[116:117], v[46:47] op_sel_hi:[1,0,1]
    v_pk_mul_f32 v[144:145], v[32:33], v[32:33]
    v_pk_mul_f32 v[148:149], v[34:35], v[34:35]
    v_pk_mul_f32 v[152:153], v[36:37], v[36:37]
    v_pk_mul_f32 v[156:157], v[38:39], v[38:39]
    v_pk_fma_f32 v[144:145], v[144:145], v[112:113], v[112:113] op_sel:[0,1,0] op_sel_hi:[1,1,0]
    v_pk_fma_f32 v[148:149], v[148:149], v[112:113], v[112:113] op_sel:[0,1,0] op_sel_hi:[1,1,0]
    v_pk_fma_f32 v[152:153], v[152:153], v[112:113], v[112:113] op_sel:[0,1,0] op_sel_hi:[1,1,0]
    v_pk_fma_f32 v[156:157], v[156:157], v[112:113], v[112:113] op_sel:[0,1,0] op_sel_hi:[1,1,0]
    v_pk_mul_f32 v[144:145], v[144:145], v[32:33]
    v_pk_mul_f32 v[148:149], v[148:149], v[34:35]
    v_pk_mul_f32 v[152:153], v[152:153], v[36:37]
    v_pk_mul_f32 v[156:157], v[156:157], v[38:39]
    v_exp_f32 v146, v144
    v_exp_f32 v147, v145
    v_exp_f32 v150, v148
    v_exp_f32 v151, v149
    v_exp_f32 v154, v152
    v_exp_f32 v155, v153
    v_exp_f32 v158, v156
    v_exp_f32 v159, v157
    v_pk_fma_f32 v[144:145], v[146:147], v[114:115], v[114:115] op_sel_hi:[1,0,0]
    v_pk_fma_f32 v[148:149], v[150:151], v[114:115], v[114:115] op_sel_hi:[1,0,0]
    v_pk_fma_f32 v[152:153], v[154:155], v[114:115], v[114:115] op_sel_hi:[1,0,0]
    v_pk_fma_f32 v[156:157], v[158:159], v[114:115], v[114:115] op_sel_hi:[1,0,0]
    v_rcp_f32 v146, v144
    v_rcp_f32 v147, v145
    v_rcp_f32 v150, v148
    v_rcp_f32 v151, v149
    v_rcp_f32 v154, v152
    v_rcp_f32 v155, v153
    v_rcp_f32 v158, v156
    v_rcp_f32 v159, v157
    v_pk_mul_f32 v[144:145], v[146:147], v[32:33]
    v_pk_mul_f32 v[148:149], v[150:151], v[34:35]
    v_pk_mul_f32 v[152:153], v[154:155], v[36:37]
    v_pk_mul_f32 v[156:157], v[158:159], v[38:39]
    v_cvt_pk_bf16_f32 v48, v144, v145
    v_cvt_pk_bf16_f32 v49, v148, v149
    v_cvt_pk_bf16_f32 v50, v152, v153
    v_cvt_pk_bf16_f32 v51, v156, v157
    v_pk_mul_f32 v[144:145], v[40:41], v[40:41]
    v_pk_mul_f32 v[148:149], v[42:43], v[42:43]
    v_pk_mul_f32 v[152:153], v[44:45], v[44:45]
    v_pk_mul_f32 v[156:157], v[46:47], v[46:47]
    v_pk_fma_f32 v[144:145], v[144:145], v[112:113], v[112:113] op_sel:[0,1,0] op_sel_hi:[1,1,0]
    v_pk_fma_f32 v[148:149], v[148:149], v[112:113], v[112:113] op_sel:[0,1,0] op_sel_hi:[1,1,0]
    v_pk_fma_f32 v[152:153], v[152:153], v[112:113], v[112:113] op_sel:[0,1,0] op_sel_hi:[1,1,0]
    v_pk_fma_f32 v[156:157], v[156:157], v[112:113], v[112:113] op_sel:[0,1,0] op_sel_hi:[1,1,0]
    v_pk_mul_f32 v[144:145], v[144:145], v[40:41]
    v_pk_mul_f32 v[148:149], v[148:149], v[42:43]
    v_pk_mul_f32 v[152:153], v[152:153], v[44:45]
    v_pk_mul_f32 v[156:157], v[156:157], v[46:47]
    v_exp_f32 v146, v144
    v_exp_f32 v147, v145
    v_exp_f32 v150, v148
    v_exp_f32 v151, v149
    v_exp_f32 v154, v152
    v_exp_f32 v155, v153
    v_exp_f32 v158, v156
    v_exp_f32 v159, v157
    v_pk_fma_f32 v[144:145], v[146:147], v[114:115], v[114:115] op_sel_hi:[1,0,0]
    v_pk_fma_f32 v[148:149], v[150:151], v[114:115], v[114:115] op_sel_hi:[1,0,0]
    v_pk_fma_f32 v[152:153], v[154:155], v[114:115], v[114:115] op_sel_hi:[1,0,0]
    v_pk_fma_f32 v[156:157], v[158:159], v[114:115], v[114:115] op_sel_hi:[1,0,0]
    v_rcp_f32 v146, v144
    v_rcp_f32 v147, v145
    v_rcp_f32 v150, v148
    v_rcp_f32 v151, v149
    v_rcp_f32 v154, v152
    v_rcp_f32 v155, v153
    v_rcp_f32 v158, v156
    v_rcp_f32 v159, v157
    v_pk_mul_f32 v[144:145], v[146:147], v[40:41]
    v_pk_mul_f32 v[148:149], v[150:151], v[42:43]
    v_pk_mul_f32 v[152:153], v[154:155], v[44:45]
    v_pk_mul_f32 v[156:157], v[158:159], v[46:47]
    v_cvt_pk_bf16_f32 v52, v144, v145
    v_cvt_pk_bf16_f32 v53, v148, v149
    v_cvt_pk_bf16_f32 v54, v152, v153
    v_cvt_pk_bf16_f32 v55, v156, v157
    s_lshl_b32 s64, s60, 15
    s_lshl_b32 s65, s53, 12
    s_lshl_b32 s78, s56, 11
    s_add_u32 s65, s65, s78
    s_add_u32 s64, s64, s65
    s_add_u32 s64, s64, 0x500000
    buffer_store_dwordx4 v[48:51], v1, s[4:7], s64 offen sc1
    buffer_store_dwordx4 v[52:55], v1, s[4:7], s64 offen offset:1024 sc1
    s_waitcnt vmcnt(9)
    v_readfirstlane_b32 s57, v30
    s_nop 0
    s_mul_i32 s57, s57, 0x9e3779b1
    s_add_u32 s57, s57, 0x7f4a7c15
    s_mul_i32 s64, s56, 49152
    s_add_u32 s64, s64, 65536
    v_add_u32 v128, s64, v2
    s_mul_i32 s64, s56, -16384
    s_add_u32 s64, s64, 98304
    v_add_u32 v129, s64, v2
    s_lshl_b32 s64, s60, 5
    v_add_u32 v26, s64, v24
    s_add_u32 s65, s56, 1
    s_lshl_b32 s64, s56, 14
    s_add_u32 s64, s64, 0x500000
    v_mov_b32 v29, 0x40000000
    v_subrev_u32 v27, s65, v26
    v_lshrrev_b32 v28, 5, v27
    v_lshlrev_b32 v28, 15, v28
    v_and_b32 v30, 31, v27
    v_lshl_add_u32 v30, v23, 5, v30
    v_lshl_add_u32 v28, v30, 4, v28
    v_add_u32 v28, s64, v28
    v_cmp_gt_u32 vcc, 0x800, v27
    s_nop 1
    v_cndmask_b32 v140, v29, v28, vcc
    v_add_u32 v27, s65, v26
    v_lshrrev_b32 v28, 5, v27
    v_lshlrev_b32 v28, 15, v28
    v_and_b32 v30, 31, v27
    v_lshl_add_u32 v30, v23, 5, v30
    v_lshl_add_u32 v28, v30, 4, v28
    v_add_u32 v28, s64, v28
    v_cmp_gt_u32 vcc, 0x800, v27
    s_nop 1
    v_cndmask_b32 v141, v29, v28, vcc
    s_waitcnt vmcnt(0)
    s_barrier
    s_lshl_b32 s65, s52, 3
    s_add_u32 s65, s65, s53
    s_cmp_lg_u32 s54, 0
    s_cbranch_scc1 L_noflag_1
    s_lshl_b32 s64, s65, 7
    s_add_u32 s64, s64, 4096
    v_mov_b32 v26, s57
    v_mov_b32 v27, s64
    s_mov_b64 exec, 1
    buffer_store_dword v26, v27, s[4:7], 0 offen sc1
    s_mov_b64 exec, -1
L_noflag_1:
    s_lshl_b32 s64, s55, 1
    s_sub_u32 s64, s64, 1
    s_add_u32 s64, s64, s52
    s_cmp_lt_u32 s64, 32
    s_cselect_b32 s64, s64, s52
    v_mov_b32 v28, s52
    v_mov_b32 v29, s64
    v_and_b32 v27, 4, v0
    v_cmp_eq_u32 vcc, 0, v27
    s_nop 1
    v_cndmask_b32 v28, v29, v28, vcc
    v_lshlrev_b32 v28, 3, v28
    v_and_b32 v29, 3, v0
    v_add_u32 v28, v28, v29
    s_lshl_b32 s64, s56, 2
    v_add_u32 v28, s64, v28
    s_barrier
    v_lshlrev_b32 v171, 7, v28
    v_add_u32 v171, 4096, v171
    buffer_load_dword v170, v171, s[4:7], 0 offen sc1
    s_waitcnt vmcnt(0)
    v_cmp_ne_u32 vcc, s57, v170
    s_nop 0
    s_cmp_eq_u64 vcc, 0
    s_cbranch_scc1 L_polled_3
    s_mov_b32 s86, 0x40000
L_poll_2:
    buffer_load_dword v170, v171, s[4:7], 0 offen sc1
    s_waitcnt vmcnt(0)
    v_cmp_ne_u32 vcc, s57, v170
    s_nop 0
    s_cmp_eq_u64 vcc, 0
    s_cbranch_scc1 L_polled_3
    s_sub_u32 s86, s86, 1
    s_cmp_lg_u32 s86, 0
    s_cbranch_scc1 L_poll_2
    v_mov_b32 v26, 0
    v_mov_b32 v27, 258
    s_mov_b64 exec, 1
    global_store_dword v26, v27, s[30:31]
    s_mov_b64 exec, -1
L_polled_3:
    buffer_load_dwordx4 a[0:3], v140, s[4:7], 0 offen offset:0 sc1
    buffer_load_dwordx4 a[4:7], v140, s[4:7], 0 offen offset:1024 sc1
    buffer_load_dwordx4 a[8:11], v140, s[4:7], 0 offen offset:2048 sc1
    buffer_load_dwordx4 a[12:15], v140, s[4:7], 0 offen offset:3072 sc1
    buffer_load_dwordx4 a[16:19], v140, s[4:7], s82 offen offset:0 sc1
    buffer_load_dwordx4 a[20:23], v140, s[4:7], s82 offen offset:1024 sc1
    buffer_load_dwordx4 a[24:27], v140, s[4:7], s82 offen offset:2048 sc1
    buffer_load_dwordx4 a[28:31], v140, s[4:7], s82 offen offset:3072 sc1
    buffer_load_dwordx4 a[32:35], v141, s[4:7], s83 offen offset:0 sc1
    buffer_load_dwordx4 a[36:39], v141, s[4:7], s83 offen offset:1024 sc1
    s_barrier
    ds_read_b64_tr_b16 v[96:97], v128 offset:0
    ds_read_b64_tr_b16 v[98:99], v128 offset:512
    ds_read_b64_tr_b16 v[104:105], v129 offset:0
    ds_read_b64_tr_b16 v[106:107], v129 offset:512
    s_waitcnt vmcnt(9) lgkmcnt(2)
    v_mfma_f32_32x32x16_bf16 v[32:47], v[96:99], a[0:3], 0
    ds_read_b64_tr_b16 v[100:101], v128 offset:1024
    ds_read_b64_tr_b16 v[102:103], v128 offset:1536
    buffer_load_dwordx4 a[40:43], v141, s[4:7], s83 offen offset:2048 sc1
    s_waitcnt lgkmcnt(2)
    v_mfma_f32_32x32x16_bf16 v[48:63], v[104:107], a[0:3], 0
    ds_read_b64_tr_b16 v[108:109], v129 offset:1024
    ds_read_b64_tr_b16 v[110:111], v129 offset:1536
    s_waitcnt vmcnt(9) lgkmcnt(2)
    v_mfma_f32_32x32x16_bf16 v[32:47], v[100:103], a[4:7], v[32:47]
    ds_read_b64_tr_b16 v[96:97], v128 offset:2048
    ds_read_b64_tr_b16 v[98:99], v128 offset:2560
    buffer_load_dwordx4 a[44:47], v141, s[4:7], s83 offen offset:3072 sc1
    s_waitcnt lgkmcnt(2)
    v_mfma_f32_32x32x16_bf16 v[48:63], v[108:111], a[4:7], v[48:63]
    ds_read_b64_tr_b16 v[104:105], v129 offset:2048
    ds_read_b64_tr_b16 v[106:107], v129 offset:2560
    s_waitcnt vmcnt(9) lgkmcnt(2)
    v_mfma_f32_32x32x16_bf16 v[32:47], v[96:99], a[8:11], v[32:47]
    ds_read_b64_tr_b16 v[100:101], v128 offset:3072
    ds_read_b64_tr_b16 v[102:103], v128 offset:3584
    buffer_load_dwordx4 a[48:51], v141, s[4:7], s84 offen offset:0 sc1
    s_waitcnt lgkmcnt(2)
    v_mfma_f32_32x32x16_bf16 v[48:63], v[104:107], a[8:11], v[48:63]
    ds_read_b64_tr_b16 v[108:109], v129 offset:3072
    ds_read_b64_tr_b16 v[110:111], v129 offset:3584
    s_waitcnt vmcnt(9) lgkmcnt(2)
    v_mfma_f32_32x32x16_bf16 v[32:47], v[100:103], a[12:15], v[32:47]
    ds_read_b64_tr_b16 v[96:97], v128 offset:4096
    ds_read_b64_tr_b16 v[98:99], v128 offset:4608
    buffer_load_dwordx4 a[52:55], v141, s[4:7], s84 offen offset:1024 sc1
    s_waitcnt lgkmcnt(2)
    v_mfma_f32_32x32x16_bf16 v[48:63], v[108:111], a[12:15], v[48:63]
    ds_read_b64_tr_b16 v[104:105], v129 offset:4096
    ds_read_b64_tr_b16 v[106:107], v129 offset:4608
    s_waitcnt vmcnt(9) lgkmcnt(2)
    v_mfma_f32_32x32x16_bf16 v[32:47], v[96:99], a[16:19], v[32:47]
    ds_read_b64_tr_b16 v[100:101], v128 offset:5120
    ds_read_b64_tr_b16 v[102:103], v128 offset:5632
    buffer_load_dwordx4 a[56:59], v141, s[4:7], s84 offen offset:2048 sc1
    s_waitcnt lgkmcnt(2)
    v_mfma_f32_32x32x16_bf16 v[48:63], v[104:107], a[16:19], v[48:63]
    ds_read_b64_tr_b16 v[108:109], v129 offset:5120
    ds_read_b64_tr_b16 v[110:111], v129 offset:5632
    s_waitcnt vmcnt(9) lgkmcnt(2)
    v_mfma_f32_32x32x16_bf16 v[32:47], v[100:103], a[20:23], v[32:47]
    ds_read_b64_tr_b16 v[96:97], v128 offset:6144
    ds_read_b64_tr_b16 v[98:99], v128 offset:6656
    buffer_load_dwordx4 a[60:63], v141, s[4:7], s84 offen offset:3072 sc1
    s_waitcnt lgkmcnt(2)
    v_mfma_f32_32x32x16_bf16 v[48:63], v[108:111], a[20:23], v[48:63]
    ds_read_b64_tr_b16 v[104:105], v129 offset:6144
    ds_read_b64_tr_b16 v[106:107], v129 offset:6656
    s_waitcnt vmcnt(9) lgkmcnt(2)
    v_mfma_f32_32x32x16_bf16 v[32:47], v[96:99], a[24:27], v[32:47]
    ds_read_b64_tr_b16 v[100:101], v128 offset:7168
    ds_read_b64_tr_b16 v[102:103], v128 offset:7680
    s_waitcnt lgkmcnt(2)
    v_mfma_f32_32x32x16_bf16 v[48:63], v[104:107], a[24:27], v[48:63]
    ds_read_b64_tr_b16 v[108:109], v129 offset:7168
    ds_read_b64_tr_b16 v[110:111], v129 offset:7680
    s_waitcnt vmcnt(8) lgkmcnt(2)
    v_mfma_f32_32x32x16_bf16 v[32:47], v[100:103], a[28:31], v[32:47]
    ds_read_b64_tr_b16 v[96:97], v128 offset:8192
    ds_read_b64_tr_b16 v[98:99], v128 offset:8704
    s_waitcnt lgkmcnt(2)
    v_mfma_f32_32x32x16_bf16 v[48:63], v[108:111], a[28:31], v[48:63]
    ds_read_b64_tr_b16 v[104:105], v129 offset:8192
    ds_read_b64_tr_b16 v[106:107], v129 offset:8704
    s_waitcnt vmcnt(7) lgkmcnt(2)
    v_mfma_f32_32x32x16_bf16 v[32:47], v[96:99], a[32:35], v[32:47]
    ds_read_b64_tr_b16 v[100:101], v128 offset:9216
    ds_read_b64_tr_b16 v[102:103], v128 offset:9728
    s_waitcnt lgkmcnt(2)
    v_mfma_f32_32x32x16_bf16 v[48:63], v[104:107], a[32:35], v[48:63]
    ds_read_b64_tr_b16 v[108:109], v129 offset:9216
    ds_read_b64_tr_b16 v[110:111], v129 offset:9728
    s_waitcnt vmcnt(6) lgkmcnt(2)
    v_mfma_f32_32x32x16_bf16 v[32:47], v[100:103], a[36:39], v[32:47]
    ds_read_b64_tr_b16 v[96:97], v128 offset:10240
    ds_read_b64_tr_b16 v[98:99], v128 offset:10752
    s_waitcnt lgkmcnt(2)
    v_mfma_f32_32x32x16_bf16 v[48:63], v[108:111], a[36:39], v[48:63]
    ds_read_b64_tr_b16 v[104:105], v129 offset:10240
    ds_read_b64_tr_b16 v[106:107], v129 offset:10752
    s_waitcnt vmcnt(5) lgkmcnt(2)
    v_mfma_f32_32x32x16_bf16 v[32:47], v[96:99], a[40:43], v[32:47]
    ds_read_b64_tr_b16 v[100:101], v128 offset:11264
    ds_read_b64_tr_b16 v[102:103], v128 offset:11776
    s_waitcnt lgkmcnt(2)
    v_mfma_f32_32x32x16_bf16 v[48:63], v[104:107], a[40:43], v[48:63]
    ds_read_b64_tr_b16 v[108:109], v129 offset:11264
    ds_read_b64_tr_b16 v[110:111], v129 offset:11776
    s_waitcnt vmcnt(4) lgkmcnt(2)
    v_mfma_f32_32x32x16_bf16 v[32:47], v[100:103], a[44:47], v[32:47]
    ds_read_b64_tr_b16 v[96:97], v128 offset:12288
    ds_read_b64_tr_b16 v[98:99], v128 offset:12800
    s_waitcnt lgkmcnt(2)
    v_mfma_f32_32x32x16_bf16 v[48:63], v[108:111], a[44:47], v[48:63]
    ds_read_b64_tr_b16 v[104:105], v129 offset:12288
    ds_read_b64_tr_b16 v[106:107], v129 offset:12800
    s_waitcnt vmcnt(3) lgkmcnt(2)
    v_mfma_f32_32x32x16_bf16 v[32:47], v[96:99], a[48:51], v[32:47]
    ds_read_b64_tr_b16 v[100:101], v128 offset:13312
    ds_read_b64_tr_b16 v[102:103], v128 offset:13824
    s_waitcnt lgkmcnt(2)
    v_mfma_f32_32x32x16_bf16 v[48:63], v[104:107], a[48:51], v[48:63]
    ds_read_b64_tr_b16 v[108:109], v129 offset:13312
    ds_read_b64_tr_b16 v[110:111], v129 offset:13824
    s_waitcnt vmcnt(2) lgkmcnt(2)
    v_mfma_f32_32x32x16_bf16 v[32:47], v[100:103], a[52:55], v[32:47]
    ds_read_b64_tr_b16 v[96:97], v128 offset:14336
    ds_read_b64_tr_b16 v[98:99], v128 offset:14848
    s_waitcnt lgkmcnt(2)
    v_mfma_f32_32x32x16_bf16 v[48:63], v[108:111], a[52:55], v[48:63]
    ds_read_b64_tr_b16 v[104:105], v129 offset:14336
    ds_read_b64_tr_b16 v[106:107], v129 offset:14848
    s_waitcnt vmcnt(1) lgkmcnt(2)
    v_mfma_f32_32x32x16_bf16 v[32:47], v[96:99], a[56:59], v[32:47]
    ds_read_b64_tr_b16 v[100:101], v128 offset:15360
    ds_read_b64_tr_b16 v[102:103], v128 offset:15872
    s_waitcnt lgkmcnt(2)
    v_mfma_f32_32x32x16_bf16 v[48:63], v[104:107], a[56:59], v[48:63]
    ds_read_b64_tr_b16 v[108:109], v129 offset:15360
    ds_read_b64_tr_b16 v[110:111], v129 offset:15872
    s_waitcnt vmcnt(0) lgkmcnt(2)
    v_mfma_f32_32x32x16_bf16 v[32:47], v[100:103], a[60:63], v[32:47]
    s_waitcnt lgkmcnt(0)
    v_mfma_f32_32x32x16_bf16 v[48:63], v[108:111], a[60:63], v[48:63]
    s_lshl_b32 s64, s54, 12
    s_add_u32 s64, s64, 139264
    v_add_u32 v26, s64, v1
    s_nop 8
    ds_write_b128 v26, v[48:51] offset:0
    ds_write_b128 v26, v[52:55] offset:1024
    ds_write_b128 v26, v[56:59] offset:2048
    ds_write_b128 v26, v[60:63] offset:3072
    v_lshlrev_b32 v96, 16, v4
    v_and_b32 v97, s81, v4
    v_lshlrev_b32 v98, 16, v5
    v_and_b32 v99, s81, v5
    v_lshlrev_b32 v100, 16, v6
    v_and_b32 v101, s81, v6
    v_lshlrev_b32 v102, 16, v7
    v_and_b32 v103, s81, v7
    v_lshlrev_b32 v104, 16, v8
    v_and_b32 v105, s81, v8
    v_lshlrev_b32 v106, 16, v9
    v_and_b32 v107, s81, v9
    v_lshlrev_b32 v108, 16, v10
    v_and_b32 v109, s81, v10
    v_lshlrev_b32 v110, 16, v11
    v_and_b32 v111, s81, v11
    v_pk_add_f32 v[96:97], v[96:97], v[20:21] op_sel_hi:[1,0] neg_lo:[0,1] neg_hi:[0,1]
    v_pk_add_f32 v[98:99], v[98:99], v[20:21] op_sel_hi:[1,0] neg_lo:[0,1] neg_hi:[0,1]
    v_pk_add_f32 v[100:101], v[100:101], v[20:21] op_sel_hi:[1,0] neg_lo:[0,1] neg_hi:[0,1]
    v_pk_add_f32 v[102:103], v[102:103], v[20:21] op_sel_hi:[1,0] neg_lo:[0,1] neg_hi:[0,1]
    v_pk_add_f32 v[104:105], v[104:105], v[20:21] op_sel_hi:[1,0] neg_lo:[0,1] neg_hi:[0,1]
    v_pk_add_f32 v[106:107], v[106:107], v[20:21] op_sel_hi:[1,0] neg_lo:[0,1] neg_hi:[0,1]
    v_pk_add_f32 v[108:109], v[108:109], v[20:21] op_sel_hi:[1,0] neg_lo:[0,1] neg_hi:[0,1]
    v_pk_add_f32 v[110:111], v[110:111], v[20:21] op_sel_hi:[1,0] neg_lo:[0,1] neg_hi:[0,1]
    v_pk_mul_f32 v[96:97], v[96:97], v[20:21] op_sel:[0,1] op_sel_hi:[1,1]
    v_pk_mul_f32 v[98:99], v[98:99], v[20:21] op_sel:[0,1] op_sel_hi:[1,1]
    v_pk_mul_f32 v[100:101], v[100:101], v[20:21] op_sel:[0,1] op_sel_hi:[1,1]
    v_pk_mul_f32 v[102:103], v[102:103], v[20:21] op_sel:[0,1] op_sel_hi:[1,1]
    v_pk_mul_f32 v[104:105], v[104:105], v[20:21] op_sel:[0,1] op_sel_hi:[1,1]
    v_pk_mul_f32 v[106:107], v[106:107], v[20:21] op_sel:[0,1] op_sel_hi:[1,1]
    v_pk_mul_f32 v[108:109], v[108:109], v[20:21] op_sel:[0,1] op_sel_hi:[1,1]
    v_pk_mul_f32 v[110:111], v[110:111], v[20:21] op_sel:[0,1] op_sel_hi:[1,1]
    s_waitcnt lgkmcnt(0)
    s_barrier
    s_xor_b32 s64, s54, 1
    s_lshl_b32 s64, s64, 12
    s_add_u32 s64, s64, 139264
    v_add_u32 v26, s64, v1
    ds_read_b128 v[80:83], v26 offset:0
    ds_read_b128 v[84:87], v26 offset:1024
    ds_read_b128 v[88:91], v26 offset:2048
    ds_read_b128 v[92:95], v26 offset:3072
    v_pk_add_f32 v[32:33], v[32:33], v[96:97]
    v_pk_add_f32 v[34:35], v[34:35], v[98:99]
    v_pk_add_f32 v[36:37], v[36:37], v[100:101]
    v_pk_add_f32 v[38:39], v[38:39], v[102:103]
    v_pk_add_f32 v[40:41], v[40:41], v[104:105]
    v_pk_add_f32 v[42:43], v[42:43], v[106:107]
    v_pk_add_f32 v[44:45], v[44:45], v[108:109]
    v_pk_add_f32 v[46:47], v[46:47], v[110:111]
    s_waitcnt lgkmcnt(0)
    v_pk_add_f32 v[32:33], v[32:33], v[80:81]
    v_pk_add_f32 v[34:35], v[34:35], v[82:83]
    v_pk_add_f32 v[36:37], v[36:37], v[84:85]
    v_pk_add_f32 v[38:39], v[38:39], v[86:87]
    v_pk_add_f32 v[40:41], v[40:41], v[88:89]
    v_pk_add_f32 v[42:43], v[42:43], v[90:91]
    v_pk_add_f32 v[44:45], v[44:45], v[92:93]
    v_pk_add_f32 v[46:47], v[46:47], v[94:95]
    v_cvt_pk_bf16_f32 v12, v32, v33
    v_cvt_pk_bf16_f32 v13, v34, v35
    v_cvt_pk_bf16_f32 v14, v36, v37
    v_cvt_pk_bf16_f32 v15, v38, v39
    v_cvt_pk_bf16_f32 v16, v40, v41
    v_cvt_pk_bf16_f32 v17, v42, v43
    v_cvt_pk_bf16_f32 v18, v44, v45
    v_cvt_pk_bf16_f32 v19, v46, v47
    s_lshl_b32 s64, s60, 15
    s_lshl_b32 s65, s53, 12
    s_lshl_b32 s78, s56, 11
    s_add_u32 s65, s65, s78
    s_add_u32 s64, s64, s65
    s_add_u32 s64, s64, 0x700000
    buffer_store_dwordx4 v[12:15], v1, s[4:7], s64 offen sc1
    buffer_store_dwordx4 v[16:19], v1, s[4:7], s64 offen offset:1024 sc1
    v_pk_mul_f32 v[112:113], v[32:33], v[32:33]
    v_pk_add_f32 v[114:115], v[32:33], v[34:35]
    v_pk_fma_f32 v[112:113], v[34:35], v[34:35], v[112:113]
    v_pk_fma_f32 v[112:113], v[36:37], v[36:37], v[112:113]
    v_pk_add_f32 v[114:115], v[114:115], v[36:37]
    v_pk_fma_f32 v[112:113], v[38:39], v[38:39], v[112:113]
    v_pk_add_f32 v[114:115], v[114:115], v[38:39]
    v_pk_fma_f32 v[112:113], v[40:41], v[40:41], v[112:113]
    v_pk_add_f32 v[114:115], v[114:115], v[40:41]
    v_pk_fma_f32 v[112:113], v[42:43], v[42:43], v[112:113]
    v_pk_add_f32 v[114:115], v[114:115], v[42:43]
    v_pk_fma_f32 v[112:113], v[44:45], v[44:45], v[112:113]
    v_pk_add_f32 v[114:115], v[114:115], v[44:45]
    v_pk_fma_f32 v[112:113], v[46:47], v[46:47], v[112:113]
    v_pk_add_f32 v[114:115], v[114:115], v[46:47]
    v_add_f32 v114, v114, v115
    v_add_f32 v112, v112, v113
    s_nop 1
    v_permlane32_swap_b32 v114, v112
    v_add_f32 v114, v114, v112
    s_lshl_b32 s64, s53, 1
    s_add_u32 s64, s64, s56
    s_lshl_b32 s64, s64, 14
    s_lshl_b32 s65, s60, 7
    s_add_u32 s64, s64, s65
    s_add_u32 s64, s64, 0x900000
    v_lshlrev_b32 v26, 13, v23
    v_lshl_add_u32 v26, v24, 2, v26
    buffer_store_dword v114, v26, s[4:7], s64 offen sc1
    s_barrier
    s_lshl_b32 s64, s55, 4
    s_sub_u32 s64, 119960, s64
    v_lshl_add_u32 v160, v0, 3, s64
    s_mul_i32 s64, s55, 2624
    s_lshl_b32 s65, s56, 5
    s_add_u32 s64, s64, s65
    s_add_u32 s64, s64, 136480
    v_bfe_u32 v26, v0, 2, 2
    v_mul_u32_u24 v26, 5312, v26
    v_and_b32 v27, 3, v0
    v_lshrrev_b32 v28, 4, v0
    v_sub_u32 v27, v27, v28
    v_lshl_add_u32 v26, v27, 3, v26
    v_add_u32 v161, s64, v26
    s_waitcnt vmcnt(0)
    s_barrier
    s_lshl_b32 s65, s52, 3
    s_add_u32 s65, s65, s53
    s_cmp_lg_u32 s54, 0
    s_cbranch_scc1 L_noflag_4
    s_lshl_b32 s64, s65, 7
    s_add_u32 s64, s64, 36864
    v_mov_b32 v26, s57
    v_mov_b32 v27, s64
    s_mov_b64 exec, 1
    buffer_store_dword v26, v27, s[4:7], 0 offen sc1
    s_mov_b64 exec, -1
L_noflag_4:
    ds_read_b64_tr_b16 v[64:65], v160 offset:8
    ds_read_b64_tr_b16 v[66:67], v160 offset:520
    ds_read_b64_tr_b16 v[96:97], v161 offset:32
    ds_read_b64_tr_b16 v[98:99], v161 offset:0
    ds_read_b64_tr_b16 v[100:101], v161 offset:96
    ds_read_b64_tr_b16 v[102:103], v161 offset:64
    ds_read_b64_tr_b16 v[104:105], v161 offset:160
    ds_read_b64_tr_b16 v[106:107], v161 offset:128
    ds_read_b64_tr_b16 v[108:109], v161 offset:224
    ds_read_b64_tr_b16 v[110:111], v161 offset:192
    ds_read_b64_tr_b16 v[68:69], v160 offset:1032
    ds_read_b64_tr_b16 v[70:71], v160 offset:1544
    ds_read_b64_tr_b16 v[72:73], v160 offset:2056
    ds_read_b64_tr_b16 v[74:75], v160 offset:2568
    ds_read_b64_tr_b16 v[76:77], v160 offset:3080
    ds_read_b64_tr_b16 v[78:79], v160 offset:3592
    s_waitcnt lgkmcnt(12)
    v_mfma_f32_16x16x32_bf16 v[32:35], v[64:67], v[96:99], 0
    ds_read_b64_tr_b16 v[80:81], v160 offset:4136
    ds_read_b64_tr_b16 v[82:83], v160 offset:4648
    s_waitcnt lgkmcnt(12)
    v_mfma_f32_16x16x32_bf16 v[36:39], v[64:67], v[100:103], 0
    ds_read_b64_tr_b16 v[112:113], v161 offset:360
    ds_read_b64_tr_b16 v[114:115], v161 offset:328
    s_waitcnt lgkmcnt(12)
    v_mfma_f32_16x16x32_bf16 v[40:43], v[64:67], v[104:107], 0
    ds_read_b64_tr_b16 v[116:117], v161 offset:424
    ds_read_b64_tr_b16 v[118:119], v161 offset:392
    s_waitcnt lgkmcnt(12)
    v_mfma_f32_16x16x32_bf16 v[44:47], v[64:67], v[108:111], 0
    ds_read_b64_tr_b16 v[120:121], v161 offset:488
    ds_read_b64_tr_b16 v[122:123], v161 offset:456
    s_waitcnt lgkmcnt(12)
    v_mfma_f32_16x16x32_bf16 v[36:39], v[68:71], v[96:99], v[36:39]
    ds_read_b64_tr_b16 v[124:125], v161 offset:552
    ds_read_b64_tr_b16 v[126:127], v161 offset:520
    v_mfma_f32_16x16x32_bf16 v[40:43], v[68:71], v[100:103], v[40:43]
    ds_read_b64_tr_b16 v[84:85], v160 offset:5160
    ds_read_b64_tr_b16 v[86:87], v160 offset:5672
    v_mfma_f32_16x16x32_bf16 v[44:47], v[68:71], v[104:107], v[44:47]
    ds_read_b64_tr_b16 v[88:89], v160 offset:6184
    s_waitcnt lgkmcnt(15)
    v_mfma_f32_16x16x32_bf16 v[40:43], v[72:75], v[96:99], v[40:43]
    ds_read_b64_tr_b16 v[90:91], v160 offset:6696
    v_mfma_f32_16x16x32_bf16 v[44:47], v[72:75], v[100:103], v[44:47]
    ds_read_b64_tr_b16 v[92:93], v160 offset:7208
    s_waitcnt lgkmcnt(15)
    v_mfma_f32_16x16x32_bf16 v[44:47], v[76:79], v[96:99], v[44:47]
    ds_read_b64_tr_b16 v[94:95], v160 offset:7720
    s_waitcnt lgkmcnt(12)
    v_mfma_f32_16x16x32_bf16 v[32:35], v[80:83], v[112:115], v[32:35]
    ds_read_b64_tr_b16 v[64:65], v160 offset:8264
    ds_read_b64_tr_b16 v[66:67], v160 offset:8776
    s_waitcnt lgkmcnt(12)
    v_mfma_f32_16x16x32_bf16 v[36:39], v[80:83], v[116:119], v[36:39]
    ds_read_b64_tr_b16 v[96:97], v161 offset:688
    ds_read_b64_tr_b16 v[98:99], v161 offset:656
    s_waitcnt lgkmcnt(12)
    v_mfma_f32_16x16x32_bf16 v[40:43], v[80:83], v[120:123], v[40:43]
    ds_read_b64_tr_b16 v[100:101], v161 offset:752
    ds_read_b64_tr_b16 v[102:103], v161 offset:720
    s_waitcnt lgkmcnt(12)
    v_mfma_f32_16x16x32_bf16 v[44:47], v[80:83], v[124:127], v[44:47]
    ds_read_b64_tr_b16 v[104:105], v161 offset:816
    ds_read_b64_tr_b16 v[106:107], v161 offset:784
    s_waitcnt lgkmcnt(12)
    v_mfma_f32_16x16x32_bf16 v[36:39], v[84:87], v[112:115], v[36:39]
    ds_read_b64_tr_b16 v[108:109], v161 offset:880
    ds_read_b64_tr_b16 v[110:111], v161 offset:848
    v_mfma_f32_16x16x32_bf16 v[40:43], v[84:87], v[116:119], v[40:43]
    ds_read_b64_tr_b16 v[68:69], v160 offset:9288
    ds_read_b64_tr_b16 v[70:71], v160 offset:9800
    v_mfma_f32_16x16x32_bf16 v[44:47], v[84:87], v[120:123], v[44:47]
    ds_read_b64_tr_b16 v[72:73], v160 offset:10312
    s_waitcnt lgkmcnt(15)
    v_mfma_f32_16x16x32_bf16 v[40:43], v[88:91], v[112:115], v[40:43]
    ds_read_b64_tr_b16 v[74:75], v160 offset:10824
    v_mfma_f32_16x16x32_bf16 v[44:47], v[88:91], v[116:119], v[44:47]
    ds_read_b64_tr_b16 v[76:77], v160 offset:11336
    s_waitcnt lgkmcnt(15)
    v_mfma_f32_16x16x32_bf16 v[44:47], v[92:95], v[112:115], v[44:47]
    ds_read_b64_tr_b16 v[78:79], v160 offset:11848
    s_waitcnt lgkmcnt(12)
    v_mfma_f32_16x16x32_bf16 v[32:35], v[64:67], v[96:99], v[32:35]
    ds_read_b64_tr_b16 v[80:81], v160 offset:12392
    ds_read_b64_tr_b16 v[82:83], v160 offset:12904
    s_waitcnt lgkmcnt(12)
    v_mfma_f32_16x16x32_bf16 v[36:39], v[64:67], v[100:103], v[36:39]
    ds_read_b64_tr_b16 v[112:113], v161 offset:1016
    ds_read_b64_tr_b16 v[114:115], v161 offset:984
    s_waitcnt lgkmcnt(12)
    v_mfma_f32_16x16x32_bf16 v[40:43], v[64:67], v[104:107], v[40:43]
    ds_read_b64_tr_b16 v[116:117], v161 offset:1080
    ds_read_b64_tr_b16 v[118:119], v161 offset:1048
    s_waitcnt lgkmcnt(12)
    v_mfma_f32_16x16x32_bf16 v[44:47], v[64:67], v[108:111], v[44:47]
    ds_read_b64_tr_b16 v[120:121], v161 offset:1144
    ds_read_b64_tr_b16 v[122:123], v161 offset:1112
    s_waitcnt lgkmcnt(12)
    v_mfma_f32_16x16x32_bf16 v[36:39], v[68:71], v[96:99], v[36:39]
    ds_read_b64_tr_b16 v[124:125], v161 offset:1208
    ds_read_b64_tr_b16 v[126:127], v161 offset:1176
    v_mfma_f32_16x16x32_bf16 v[40:43], v[68:71], v[100:103], v[40:43]
    ds_read_b64_tr_b16 v[84:85], v160 offset:13416
    ds_read_b64_tr_b16 v[86:87], v160 offset:13928
    v_mfma_f32_16x16x32_bf16 v[44:47], v[68:71], v[104:107], v[44:47]
    ds_read_b64_tr_b16 v[88:89], v160 offset:14440
    s_waitcnt lgkmcnt(15)
    v_mfma_f32_16x16x32_bf16 v[40:43], v[72:75], v[96:99], v[40:43]
    ds_read_b64_tr_b16 v[90:91], v160 offset:14952
    v_mfma_f32_16x16x32_bf16 v[44:47], v[72:75], v[100:103], v[44:47]
    ds_read_b64_tr_b16 v[92:93], v160 offset:15464
    s_waitcnt lgkmcnt(15)
    v_mfma_f32_16x16x32_bf16 v[44:47], v[76:79], v[96:99], v[44:47]
    ds_read_b64_tr_b16 v[94:95], v160 offset:15976
    s_waitcnt lgkmcnt(12)
    v_mfma_f32_16x16x32_bf16 v[32:35], v[80:83], v[112:115], v[32:35]
    ds_read_b64_tr_b16 v[64:65], v160 offset:0
    ds_read_b64_tr_b16 v[66:67], v160 offset:512
    s_waitcnt lgkmcnt(12)
    v_mfma_f32_16x16x32_bf16 v[36:39], v[80:83], v[116:119], v[36:39]
    ds_read_b64_tr_b16 v[96:97], v161 offset:1344
    ds_read_b64_tr_b16 v[98:99], v161 offset:1312
    s_waitcnt lgkmcnt(12)
    v_mfma_f32_16x16x32_bf16 v[40:43], v[80:83], v[120:123], v[40:43]
    ds_read_b64_tr_b16 v[100:101], v161 offset:1408
    ds_read_b64_tr_b16 v[102:103], v161 offset:1376
    s_waitcnt lgkmcnt(12)
    v_mfma_f32_16x16x32_bf16 v[44:47], v[80:83], v[124:127], v[44:47]
    ds_read_b64_tr_b16 v[104:105], v161 offset:1472
    ds_read_b64_tr_b16 v[106:107], v161 offset:1440
    s_waitcnt lgkmcnt(12)
    v_mfma_f32_16x16x32_bf16 v[36:39], v[84:87], v[112:115], v[36:39]
    ds_read_b64_tr_b16 v[108:109], v161 offset:1536
    ds_read_b64_tr_b16 v[110:111], v161 offset:1504
    v_mfma_f32_16x16x32_bf16 v[40:43], v[84:87], v[116:119], v[40:43]
    ds_read_b64_tr_b16 v[68:69], v160 offset:1024
    ds_read_b64_tr_b16 v[70:71], v160 offset:1536
    v_mfma_f32_16x16x32_bf16 v[44:47], v[84:87], v[120:123], v[44:47]
    ds_read_b64_tr_b16 v[72:73], v160 offset:2048
    s_waitcnt lgkmcnt(15)
    v_mfma_f32_16x16x32_bf16 v[40:43], v[88:91], v[112:115], v[40:43]
    ds_read_b64_tr_b16 v[74:75], v160 offset:2560
    v_mfma_f32_16x16x32_bf16 v[44:47], v[88:91], v[116:119], v[44:47]
    ds_read_b64_tr_b16 v[76:77], v160 offset:3072
    s_waitcnt lgkmcnt(15)
    v_mfma_f32_16x16x32_bf16 v[44:47], v[92:95], v[112:115], v[44:47]
    ds_read_b64_tr_b16 v[78:79], v160 offset:3584
    s_waitcnt lgkmcnt(12)
    v_mfma_f32_16x16x32_bf16 v[32:35], v[64:67], v[96:99], v[32:35]
    ds_read_b64_tr_b16 v[80:81], v160 offset:4128
    ds_read_b64_tr_b16 v[82:83], v160 offset:4640
    s_waitcnt lgkmcnt(12)
    v_mfma_f32_16x16x32_bf16 v[36:39], v[64:67], v[100:103], v[36:39]
    ds_read_b64_tr_b16 v[112:113], v161 offset:1672
    ds_read_b64_tr_b16 v[114:115], v161 offset:1640
    s_waitcnt lgkmcnt(12)
    v_mfma_f32_16x16x32_bf16 v[40:43], v[64:67], v[104:107], v[40:43]
    ds_read_b64_tr_b16 v[116:117], v161 offset:1736
    ds_read_b64_tr_b16 v[118:119], v161 offset:1704
    s_waitcnt lgkmcnt(12)
    v_mfma_f32_16x16x32_bf16 v[44:47], v[64:67], v[108:111], v[44:47]
    ds_read_b64_tr_b16 v[120:121], v161 offset:1800
    ds_read_b64_tr_b16 v[122:123], v161 offset:1768
    s_waitcnt lgkmcnt(12)
    v_mfma_f32_16x16x32_bf16 v[36:39], v[68:71], v[96:99], v[36:39]
    ds_read_b64_tr_b16 v[124:125], v161 offset:1864
    ds_read_b64_tr_b16 v[126:127], v161 offset:1832
    v_mfma_f32_16x16x32_bf16 v[40:43], v[68:71], v[100:103], v[40:43]
    ds_read_b64_tr_b16 v[84:85], v160 offset:5152
    ds_read_b64_tr_b16 v[86:87], v160 offset:5664
    v_mfma_f32_16x16x32_bf16 v[44:47], v[68:71], v[104:107], v[44:47]
    ds_read_b64_tr_b16 v[88:89], v160 offset:6176
    s_waitcnt lgkmcnt(15)
    v_mfma_f32_16x16x32_bf16 v[40:43], v[72:75], v[96:99], v[40:43]
    ds_read_b64_tr_b16 v[90:91], v160 offset:6688
    v_mfma_f32_16x16x32_bf16 v[44:47], v[72:75], v[100:103], v[44:47]
    ds_read_b64_tr_b16 v[92:93], v160 offset:7200
    s_waitcnt lgkmcnt(15)
    v_mfma_f32_16x16x32_bf16 v[44:47], v[76:79], v[96:99], v[44:47]
    ds_read_b64_tr_b16 v[94:95], v160 offset:7712
    s_waitcnt lgkmcnt(12)
    v_mfma_f32_16x16x32_bf16 v[32:35], v[80:83], v[112:115], v[32:35]
    ds_read_b64_tr_b16 v[64:65], v160 offset:8256
    ds_read_b64_tr_b16 v[66:67], v160 offset:8768
    s_waitcnt lgkmcnt(12)
    v_mfma_f32_16x16x32_bf16 v[36:39], v[80:83], v[116:119], v[36:39]
    ds_read_b64_tr_b16 v[96:97], v161 offset:2000
    ds_read_b64_tr_b16 v[98:99], v161 offset:1968
    s_waitcnt lgkmcnt(12)
    v_mfma_f32_16x16x32_bf16 v[40:43], v[80:83], v[120:123], v[40:43]
    ds_read_b64_tr_b16 v[100:101], v161 offset:2064
    ds_read_b64_tr_b16 v[102:103], v161 offset:2032
    s_waitcnt lgkmcnt(12)
    v_mfma_f32_16x16x32_bf16 v[44:47], v[80:83], v[124:127], v[44:47]
    ds_read_b64_tr_b16 v[104:105], v161 offset:2128
    ds_read_b64_tr_b16 v[106:107], v161 offset:2096
    s_waitcnt lgkmcnt(12)
    v_mfma_f32_16x16x32_bf16 v[36:39], v[84:87], v[112:115], v[36:39]
    ds_read_b64_tr_b16 v[108:109], v161 offset:2192
    ds_read_b64_tr_b16 v[110:111], v161 offset:2160
    v_mfma_f32_16x16x32_bf16 v[40:43], v[84:87], v[116:119], v[40:43]
    ds_read_b64_tr_b16 v[68:69], v160 offset:9280
    ds_read_b64_tr_b16 v[70:71], v160 offset:9792
    v_mfma_f32_16x16x32_bf16 v[44:47], v[84:87], v[120:123], v[44:47]
    ds_read_b64_tr_b16 v[72:73], v160 offset:10304
    s_waitcnt lgkmcnt(15)
    v_mfma_f32_16x16x32_bf16 v[40:43], v[88:91], v[112:115], v[40:43]
    ds_read_b64_tr_b16 v[74:75], v160 offset:10816
    v_mfma_f32_16x16x32_bf16 v[44:47], v[88:91], v[116:119], v[44:47]
    ds_read_b64_tr_b16 v[76:77], v160 offset:11328
    s_waitcnt lgkmcnt(15)
    v_mfma_f32_16x16x32_bf16 v[44:47], v[92:95], v[112:115], v[44:47]
    ds_read_b64_tr_b16 v[78:79], v160 offset:11840
    s_lshr_b32 s64, s61, 1
    s_lshl_b32 s64, s64, 3
    v_and_b32 v28, 7, v0
    v_add_u32 v28, s64, v28
    v_lshlrev_b32 v171, 7, v28
    v_add_u32 v171, 36864, v171
    buffer_load_dword v170, v171, s[4:7], 0 offen sc1
    s_waitcnt lgkmcnt(12)
    v_mfma_f32_16x16x32_bf16 v[32:35], v[64:67], v[96:99], v[32:35]
    ds_read_b64_tr_b16 v[80:81], v160 offset:12384
    ds_read_b64_tr_b16 v[82:83], v160 offset:12896
    s_waitcnt lgkmcnt(12)
    v_mfma_f32_16x16x32_bf16 v[36:39], v[64:67], v[100:103], v[36:39]
    ds_read_b64_tr_b16 v[112:113], v161 offset:2328
    ds_read_b64_tr_b16 v[114:115], v161 offset:2296
    s_waitcnt lgkmcnt(12)
    v_mfma_f32_16x16x32_bf16 v[40:43], v[64:67], v[104:107], v[40:43]
    ds_read_b64_tr_b16 v[116:117], v161 offset:2392
    ds_read_b64_tr_b16 v[118:119], v161 offset:2360
    s_waitcnt lgkmcnt(12)
    v_mfma_f32_16x16x32_bf16 v[44:47], v[64:67], v[108:111], v[44:47]
    ds_read_b64_tr_b16 v[120:121], v161 offset:2456
    ds_read_b64_tr_b16 v[122:123], v161 offset:2424
    s_waitcnt lgkmcnt(12)
    v_mfma_f32_16x16x32_bf16 v[36:39], v[68:71], v[96:99], v[36:39]
    ds_read_b64_tr_b16 v[124:125], v161 offset:2520
    ds_read_b64_tr_b16 v[126:127], v161 offset:2488
    v_mfma_f32_16x16x32_bf16 v[40:43], v[68:71], v[100:103], v[40:43]
    ds_read_b64_tr_b16 v[84:85], v160 offset:13408
    ds_read_b64_tr_b16 v[86:87], v160 offset:13920
    v_mfma_f32_16x16x32_bf16 v[44:47], v[68:71], v[104:107], v[44:47]
    ds_read_b64_tr_b16 v[88:89], v160 offset:14432
    s_waitcnt lgkmcnt(15)
    v_mfma_f32_16x16x32_bf16 v[40:43], v[72:75], v[96:99], v[40:43]
    ds_read_b64_tr_b16 v[90:91], v160 offset:14944
    v_mfma_f32_16x16x32_bf16 v[44:47], v[72:75], v[100:103], v[44:47]
    ds_read_b64_tr_b16 v[92:93], v160 offset:15456
    s_waitcnt lgkmcnt(15)
    v_mfma_f32_16x16x32_bf16 v[44:47], v[76:79], v[96:99], v[44:47]
    ds_read_b64_tr_b16 v[94:95], v160 offset:15968
    s_waitcnt lgkmcnt(12)
    v_mfma_f32_16x16x32_bf16 v[32:35], v[80:83], v[112:115], v[32:35]
    s_waitcnt lgkmcnt(10)
    v_mfma_f32_16x16x32_bf16 v[36:39], v[80:83], v[116:119], v[36:39]
    s_waitcnt lgkmcnt(8)
    v_mfma_f32_16x16x32_bf16 v[40:43], v[80:83], v[120:123], v[40:43]
    s_waitcnt lgkmcnt(6)
    v_mfma_f32_16x16x32_bf16 v[44:47], v[80:83], v[124:127], v[44:47]
    s_waitcnt lgkmcnt(4)
    v_mfma_f32_16x16x32_bf16 v[36:39], v[84:87], v[112:115], v[36:39]
    v_mfma_f32_16x16x32_bf16 v[40:43], v[84:87], v[116:119], v[40:43]
    v_mfma_f32_16x16x32_bf16 v[44:47], v[84:87], v[120:123], v[44:47]
    s_waitcnt lgkmcnt(2)
    v_mfma_f32_16x16x32_bf16 v[40:43], v[88:91], v[112:115], v[40:43]
    v_mfma_f32_16x16x32_bf16 v[44:47], v[88:91], v[116:119], v[44:47]
    s_waitcnt lgkmcnt(0)
    v_mfma_f32_16x16x32_bf16 v[44:47], v[92:95], v[112:115], v[44:47]
    s_lshl_b32 s79, s61, 15
    s_add_u32 s79, s79, 0x700000
    s_barrier
    s_lshl_b32 s64, s54, 11
    s_add_u32 s64, s64, 119936
    v_add_u32 v26, s64, v1
    s_cmp_lg_u32 s55, 0
    s_cbranch_scc1 L_cvhi_5
    ds_write_b128 v26, v[40:43] offset:0
    ds_write_b128 v26, v[44:47] offset:1024
    s_branch L_cvsent_6
L_cvhi_5:
    ds_write_b128 v26, v[32:35] offset:0
    ds_write_b128 v26, v[36:39] offset:1024
L_cvsent_6:
    s_lshl_b32 s68, s55, 2
    s_add_u32 s68, s68, s56
    s_lshl_b32 s68, s68, 9
    s_add_u32 s64, s68, 115840
    v_and_b32 v27, 15, v0
    v_lshlrev_b32 v27, 5, v27
    v_lshrrev_b32 v28, 4, v0
    v_lshl_add_u32 v27, v28, 3, v27
    v_add_u32 v27, s64, v27
    ds_read_b64 v[100:101], v27 offset:0
    ds_read_b64 v[102:103], v27 offset:1024
    s_waitcnt lgkmcnt(0)
    s_barrier
    s_xor_b32 s64, s54, 2
    s_lshl_b32 s64, s64, 11
    s_add_u32 s64, s64, 119936
    v_add_u32 v26, s64, v1
    ds_read_b128 v[72:75], v26 offset:0
    ds_read_b128 v[76:79], v26 offset:1024
    v_lshlrev_b32 v104, 16, v100
    v_and_b32 v105, s81, v100
    v_lshlrev_b32 v106, 16, v101
    v_and_b32 v107, s81, v101
    v_lshlrev_b32 v108, 16, v102
    v_and_b32 v109, s81, v102
    v_lshlrev_b32 v110, 16, v103
    v_and_b32 v111, s81, v103
    v_mov_b32 v112, s62
    v_lshrrev_b32 v26, 4, v0
    v_and_b32 v27, 1, v26
    v_lshlrev_b32 v27, 10, v27
    v_lshrrev_b32 v26, 1, v26
    v_lshl_add_u32 v27, v26, 4, v27
    v_and_b32 v26, 15, v0
    v_lshl_add_u32 v27, v26, 5, v27
    v_add_u32 v27, s68, v27
    s_lshl_b32 s64, s2, 13
    s_add_u32 s64, s64, 0x300000
    s_waitcnt lgkmcnt(0)
    s_cmp_lg_u32 s55, 0
    s_cbranch_scc1 L_cvhi_7
    v_pk_add_f32 v[64:65], v[32:33], v[72:73]
    v_pk_add_f32 v[66:67], v[34:35], v[74:75]
    v_pk_add_f32 v[68:69], v[36:37], v[76:77]
    v_pk_add_f32 v[70:71], v[38:39], v[78:79]
    s_branch L_cvsum_8
L_cvhi_7:
    v_pk_add_f32 v[64:65], v[40:41], v[72:73]
    v_pk_add_f32 v[66:67], v[42:43], v[74:75]
    v_pk_add_f32 v[68:69], v[44:45], v[76:77]
    v_pk_add_f32 v[70:71], v[46:47], v[78:79]
L_cvsum_8:
    v_pk_fma_f32 v[64:65], v[104:105], v[112:113], v[64:65] op_sel_hi:[1,0,1]
    v_pk_fma_f32 v[66:67], v[106:107], v[112:113], v[66:67] op_sel_hi:[1,0,1]
    v_pk_fma_f32 v[68:69], v[108:109], v[112:113], v[68:69] op_sel_hi:[1,0,1]
    v_pk_fma_f32 v[70:71], v[110:111], v[112:113], v[70:71] op_sel_hi:[1,0,1]
    v_cvt_pk_bf16_f32 v116, v64, v65
    v_cvt_pk_bf16_f32 v117, v66, v67
    v_cvt_pk_bf16_f32 v118, v68, v69
    v_cvt_pk_bf16_f32 v119, v70, v71
    s_nop 0
    v_permlane16_swap_b32 v116, v118
    v_permlane16_swap_b32 v117, v119
    buffer_store_dwordx4 v[116:119], v27, s[4:7], s64 offen sc1
    s_barrier
    v_add_u32 v144, 0, v2
    v_add_u32 v145, 65536, v2
    v_bfe_u32 v26, v0, 2, 2
    v_lshl_add_u32 v26, v23, 2, v26
    v_and_b32 v27, 3, v0
    v_lshlrev_b32 v27, 3, v27
    v_lshl_add_u32 v26, v26, 5, v27
    v_add_u32 v146, 98304, v26
    s_waitcnt vmcnt(1)
    v_cmp_ne_u32 vcc, s57, v170
    s_nop 0
    s_cmp_eq_u64 vcc, 0
    s_cbranch_scc1 L_polled_10
    s_mov_b32 s86, 0x40000
L_poll_9:
    buffer_load_dword v170, v171, s[4:7], 0 offen sc1
    s_waitcnt vmcnt(0)
    v_cmp_ne_u32 vcc, s57, v170
    s_nop 0
    s_cmp_eq_u64 vcc, 0
    s_cbranch_scc1 L_polled_10
    s_sub_u32 s86, s86, 1
    s_cmp_lg_u32 s86, 0
    s_cbranch_scc1 L_poll_9
    v_mov_b32 v26, 0
    v_mov_b32 v27, 259
    s_mov_b64 exec, 1
    global_store_dword v26, v27, s[30:31]
    s_mov_b64 exec, -1
L_polled_10:
    buffer_load_dwordx4 a[0:3], v1, s[4:7], s79 offen offset:0 sc1
    buffer_load_dwordx4 a[4:7], v1, s[4:7], s79 offen offset:1024 sc1
    buffer_load_dwordx4 a[8:11], v1, s[4:7], s79 offen offset:2048 sc1
    buffer_load_dwordx4 a[12:15], v1, s[4:7], s79 offen offset:3072 sc1
    s_add_u32 s79, s79, 0x1000
    buffer_load_dwordx4 a[16:19], v1, s[4:7], s79 offen offset:0 sc1
    buffer_load_dwordx4 a[20:23], v1, s[4:7], s79 offen offset:1024 sc1
    buffer_load_dwordx4 a[24:27], v1, s[4:7], s79 offen offset:2048 sc1
    buffer_load_dwordx4 a[28:31], v1, s[4:7], s79 offen offset:3072 sc1
    s_add_u32 s79, s79, 0x1000
    buffer_load_dwordx4 a[32:35], v1, s[4:7], s79 offen offset:0 sc1
    buffer_load_dwordx4 a[36:39], v1, s[4:7], s79 offen offset:1024 sc1
    buffer_load_dwordx4 a[40:43], v1, s[4:7], s79 offen offset:2048 sc1
    buffer_load_dwordx4 a[44:47], v1, s[4:7], s79 offen offset:3072 sc1
    v_lshlrev_b32 v147, 13, v23
    v_lshl_add_u32 v147, v24, 2, v147
    ds_read_b64_tr_b16 v[96:97], v144 offset:0
    ds_read_b64_tr_b16 v[98:99], v144 offset:512
    ds_read_b64_tr_b16 v[100:101], v144 offset:32768
    ds_read_b64_tr_b16 v[102:103], v144 offset:33280
    ds_read_b64_tr_b16 v[104:105], v145 offset:0
    ds_read_b64_tr_b16 v[106:107], v145 offset:512
    ds_read_b64_tr_b16 v[108:109], v146 offset:0
    ds_read_b64_tr_b16 v[110:111], v146 offset:256
    s_waitcnt vmcnt(11) lgkmcnt(6)
    v_mfma_f32_32x32x16_bf16 v[32:47], v[96:99], a[0:3], 0
    ds_read_b64_tr_b16 v[112:113], v144 offset:1024
    ds_read_b64_tr_b16 v[114:115], v144 offset:1536
    s_add_u32 s79, s79, 0x1000
    buffer_load_dwordx4 a[48:51], v1, s[4:7], s79 offen offset:0 sc1
    s_waitcnt lgkmcnt(6)
    v_mfma_f32_32x32x16_bf16 v[48:63], v[100:103], a[0:3], 0
    ds_read_b64_tr_b16 v[116:117], v144 offset:33792
    ds_read_b64_tr_b16 v[118:119], v144 offset:34304
    s_waitcnt lgkmcnt(6)
    v_mfma_f32_32x32x16_bf16 v[64:79], v[104:107], a[0:3], 0
    ds_read_b64_tr_b16 v[120:121], v145 offset:1024
    ds_read_b64_tr_b16 v[122:123], v145 offset:1536
    s_lshl_b32 s78, s61, 7
    s_add_u32 s78, s78, 0x900000
    buffer_load_dword v172, v147, s[4:7], s78 offen sc1
    s_waitcnt lgkmcnt(6)
    v_mfma_f32_32x32x16_bf16 v[80:95], v[108:111], a[0:3], 0
    ds_read_b64_tr_b16 v[124:125], v146 offset:512
    ds_read_b64_tr_b16 v[126:127], v146 offset:768
    s_waitcnt vmcnt(12) lgkmcnt(6)
    v_mfma_f32_32x32x16_bf16 v[32:47], v[112:115], a[4:7], v[32:47]
    ds_read_b64_tr_b16 v[96:97], v144 offset:2048
    ds_read_b64_tr_b16 v[98:99], v144 offset:2560
    buffer_load_dwordx4 a[52:55], v1, s[4:7], s79 offen offset:1024 sc1
    s_waitcnt lgkmcnt(6)
    v_mfma_f32_32x32x16_bf16 v[48:63], v[116:119], a[4:7], v[48:63]
    ds_read_b64_tr_b16 v[100:101], v144 offset:34816
    ds_read_b64_tr_b16 v[102:103], v144 offset:35328
    s_waitcnt lgkmcnt(6)
    v_mfma_f32_32x32x16_bf16 v[64:79], v[120:123], a[4:7], v[64:79]
    ds_read_b64_tr_b16 v[104:105], v145 offset:2048
    ds_read_b64_tr_b16 v[106:107], v145 offset:2560
    s_lshl_b32 s78, s61, 7
    s_add_u32 s78, s78, 0x904000
    buffer_load_dword v173, v147, s[4:7], s78 offen sc1
    s_waitcnt lgkmcnt(6)
    v_mfma_f32_32x32x16_bf16 v[80:95], v[124:127], a[4:7], v[80:95]
    ds_read_b64_tr_b16 v[108:109], v146 offset:1024
    ds_read_b64_tr_b16 v[110:111], v146 offset:1280
    s_waitcnt vmcnt(13) lgkmcnt(6)
    v_mfma_f32_32x32x16_bf16 v[32:47], v[96:99], a[8:11], v[32:47]
    ds_read_b64_tr_b16 v[112:113], v144 offset:3072
    ds_read_b64_tr_b16 v[114:115], v144 offset:3584
    buffer_load_dwordx4 a[56:59], v1, s[4:7], s79 offen offset:2048 sc1
    s_waitcnt lgkmcnt(6)
    v_mfma_f32_32x32x16_bf16 v[48:63], v[100:103], a[8:11], v[48:63]
    ds_read_b64_tr_b16 v[116:117], v144 offset:35840
    ds_read_b64_tr_b16 v[118:119], v144 offset:36352
    s_waitcnt lgkmcnt(6)
    v_mfma_f32_32x32x16_bf16 v[64:79], v[104:107], a[8:11], v[64:79]
    ds_read_b64_tr_b16 v[120:121], v145 offset:3072
    ds_read_b64_tr_b16 v[122:123], v145 offset:3584
    s_lshl_b32 s78, s61, 7
    s_add_u32 s78, s78, 0x908000
    buffer_load_dword v174, v147, s[4:7], s78 offen sc1
    s_waitcnt lgkmcnt(6)
    v_mfma_f32_32x32x16_bf16 v[80:95], v[108:111], a[8:11], v[80:95]
    ds_read_b64_tr_b16 v[124:125], v146 offset:1536
    ds_read_b64_tr_b16 v[126:127], v146 offset:1792
    s_waitcnt vmcnt(14) lgkmcnt(6)
    v_mfma_f32_32x32x16_bf16 v[32:47], v[112:115], a[12:15], v[32:47]
    ds_read_b64_tr_b16 v[96:97], v144 offset:4096
    ds_read_b64_tr_b16 v[98:99], v144 offset:4608
    buffer_load_dwordx4 a[60:63], v1, s[4:7], s79 offen offset:3072 sc1
    s_waitcnt lgkmcnt(6)
    v_mfma_f32_32x32x16_bf16 v[48:63], v[116:119], a[12:15], v[48:63]
    ds_read_b64_tr_b16 v[100:101], v144 offset:36864
    ds_read_b64_tr_b16 v[102:103], v144 offset:37376
    s_waitcnt lgkmcnt(6)
    v_mfma_f32_32x32x16_bf16 v[64:79], v[120:123], a[12:15], v[64:79]
    ds_read_b64_tr_b16 v[104:105], v145 offset:4096
    ds_read_b64_tr_b16 v[106:107], v145 offset:4608
    s_lshl_b32 s78, s61, 7
    s_add_u32 s78, s78, 0x90c000
    buffer_load_dword v175, v147, s[4:7], s78 offen sc1
    s_waitcnt lgkmcnt(6)
    v_mfma_f32_32x32x16_bf16 v[80:95], v[124:127], a[12:15], v[80:95]
    ds_read_b64_tr_b16 v[108:109], v146 offset:2048
    ds_read_b64_tr_b16 v[110:111], v146 offset:2304
    s_waitcnt vmcnt(15) lgkmcnt(6)
    v_mfma_f32_32x32x16_bf16 v[32:47], v[96:99], a[16:19], v[32:47]
    ds_read_b64_tr_b16 v[112:113], v144 offset:5120
    ds_read_b64_tr_b16 v[114:115], v144 offset:5632
    s_add_u32 s79, s79, 0x1000
    buffer_load_dwordx4 a[0:3], v1, s[4:7], s79 offen offset:0 sc1
    s_waitcnt lgkmcnt(6)
    v_mfma_f32_32x32x16_bf16 v[48:63], v[100:103], a[16:19], v[48:63]
    ds_read_b64_tr_b16 v[116:117], v144 offset:37888
    ds_read_b64_tr_b16 v[118:119], v144 offset:38400
    s_waitcnt lgkmcnt(6)
    v_mfma_f32_32x32x16_bf16 v[64:79], v[104:107], a[16:19], v[64:79]
    ds_read_b64_tr_b16 v[120:121], v145 offset:5120
    ds_read_b64_tr_b16 v[122:123], v145 offset:5632
    s_lshl_b32 s78, s61, 7
    s_add_u32 s78, s78, 0x910000
    buffer_load_dword v176, v147, s[4:7], s78 offen sc1
    s_waitcnt lgkmcnt(6)
    v_mfma_f32_32x32x16_bf16 v[80:95], v[108:111], a[16:19], v[80:95]
    ds_read_b64_tr_b16 v[124:125], v146 offset:2560
    ds_read_b64_tr_b16 v[126:127], v146 offset:2816
    s_waitcnt vmcnt(16) lgkmcnt(6)
    v_mfma_f32_32x32x16_bf16 v[32:47], v[112:115], a[20:23], v[32:47]
    ds_read_b64_tr_b16 v[96:97], v144 offset:6144
    ds_read_b64_tr_b16 v[98:99], v144 offset:6656
    buffer_load_dwordx4 a[4:7], v1, s[4:7], s79 offen offset:1024 sc1
    s_waitcnt lgkmcnt(6)
    v_mfma_f32_32x32x16_bf16 v[48:63], v[116:119], a[20:23], v[48:63]
    ds_read_b64_tr_b16 v[100:101], v144 offset:38912
    ds_read_b64_tr_b16 v[102:103], v144 offset:39424
    s_waitcnt lgkmcnt(6)
    v_mfma_f32_32x32x16_bf16 v[64:79], v[120:123], a[20:23], v[64:79]
    ds_read_b64_tr_b16 v[104:105], v145 offset:6144
    ds_read_b64_tr_b16 v[106:107], v145 offset:6656
    s_lshl_b32 s78, s61, 7
    s_add_u32 s78, s78, 0x914000
    buffer_load_dword v177, v147, s[4:7], s78 offen sc1
    s_waitcnt lgkmcnt(6)
    v_mfma_f32_32x32x16_bf16 v[80:95], v[124:127], a[20:23], v[80:95]
    ds_read_b64_tr_b16 v[108:109], v146 offset:3072
    ds_read_b64_tr_b16 v[110:111], v146 offset:3328
    s_waitcnt vmcnt(17) lgkmcnt(6)
    v_mfma_f32_32x32x16_bf16 v[32:47], v[96:99], a[24:27], v[32:47]
    ds_read_b64_tr_b16 v[112:113], v144 offset:7168
    ds_read_b64_tr_b16 v[114:115], v144 offset:7680
    buffer_load_dwordx4 a[8:11], v1, s[4:7], s79 offen offset:2048 sc1
    s_waitcnt lgkmcnt(6)
    v_mfma_f32_32x32x16_bf16 v[48:63], v[100:103], a[24:27], v[48:63]
    ds_read_b64_tr_b16 v[116:117], v144 offset:39936
    ds_read_b64_tr_b16 v[118:119], v144 offset:40448
    s_waitcnt lgkmcnt(6)
    v_mfma_f32_32x32x16_bf16 v[64:79], v[104:107], a[24:27], v[64:79]
    ds_read_b64_tr_b16 v[120:121], v145 offset:7168
    ds_read_b64_tr_b16 v[122:123], v145 offset:7680
    s_lshl_b32 s78, s61, 7
    s_add_u32 s78, s78, 0x918000
    buffer_load_dword v178, v147, s[4:7], s78 offen sc1
    s_waitcnt lgkmcnt(6)
    v_mfma_f32_32x32x16_bf16 v[80:95], v[108:111], a[24:27], v[80:95]
    ds_read_b64_tr_b16 v[124:125], v146 offset:3584
    ds_read_b64_tr_b16 v[126:127], v146 offset:3840
    s_waitcnt vmcnt(18) lgkmcnt(6)
    v_mfma_f32_32x32x16_bf16 v[32:47], v[112:115], a[28:31], v[32:47]
    ds_read_b64_tr_b16 v[96:97], v144 offset:8192
    ds_read_b64_tr_b16 v[98:99], v144 offset:8704
    buffer_load_dwordx4 a[12:15], v1, s[4:7], s79 offen offset:3072 sc1
    s_waitcnt lgkmcnt(6)
    v_mfma_f32_32x32x16_bf16 v[48:63], v[116:119], a[28:31], v[48:63]
    ds_read_b64_tr_b16 v[100:101], v144 offset:40960
    ds_read_b64_tr_b16 v[102:103], v144 offset:41472
    s_waitcnt lgkmcnt(6)
    v_mfma_f32_32x32x16_bf16 v[64:79], v[120:123], a[28:31], v[64:79]
    ds_read_b64_tr_b16 v[104:105], v145 offset:8192
    ds_read_b64_tr_b16 v[106:107], v145 offset:8704
    s_lshl_b32 s78, s61, 7
    s_add_u32 s78, s78, 0x91c000
    buffer_load_dword v179, v147, s[4:7], s78 offen sc1
    s_waitcnt lgkmcnt(6)
    v_mfma_f32_32x32x16_bf16 v[80:95], v[124:127], a[28:31], v[80:95]
    ds_read_b64_tr_b16 v[108:109], v146 offset:4096
    ds_read_b64_tr_b16 v[110:111], v146 offset:4352
    s_waitcnt vmcnt(19) lgkmcnt(6)
    v_mfma_f32_32x32x16_bf16 v[32:47], v[96:99], a[32:35], v[32:47]
    ds_read_b64_tr_b16 v[112:113], v144 offset:9216
    ds_read_b64_tr_b16 v[114:115], v144 offset:9728
    s_add_u32 s79, s79, 0x1000
    buffer_load_dwordx4 a[16:19], v1, s[4:7], s79 offen offset:0 sc1
    s_waitcnt lgkmcnt(6)
    v_mfma_f32_32x32x16_bf16 v[48:63], v[100:103], a[32:35], v[48:63]
    ds_read_b64_tr_b16 v[116:117], v144 offset:41984
    ds_read_b64_tr_b16 v[118:119], v144 offset:42496
    s_waitcnt lgkmcnt(6)
    v_mfma_f32_32x32x16_bf16 v[64:79], v[104:107], a[32:35], v[64:79]
    ds_read_b64_tr_b16 v[120:121], v145 offset:9216
    ds_read_b64_tr_b16 v[122:123], v145 offset:9728
    s_lshl_b32 s78, s61, 7
    s_add_u32 s78, s78, 0x920000
    buffer_load_dword v180, v147, s[4:7], s78 offen sc1
    s_waitcnt lgkmcnt(6)
    v_mfma_f32_32x32x16_bf16 v[80:95], v[108:111], a[32:35], v[80:95]
    ds_read_b64_tr_b16 v[124:125], v146 offset:4608
    ds_read_b64_tr_b16 v[126:127], v146 offset:4864
    s_waitcnt vmcnt(20) lgkmcnt(6)
    v_mfma_f32_32x32x16_bf16 v[32:47], v[112:115], a[36:39], v[32:47]
    ds_read_b64_tr_b16 v[96:97], v144 offset:10240
    ds_read_b64_tr_b16 v[98:99], v144 offset:10752
    buffer_load_dwordx4 a[20:23], v1, s[4:7], s79 offen offset:1024 sc1
    s_waitcnt lgkmcnt(6)
    v_mfma_f32_32x32x16_bf16 v[48:63], v[116:119], a[36:39], v[48:63]
    ds_read_b64_tr_b16 v[100:101], v144 offset:43008
    ds_read_b64_tr_b16 v[102:103], v144 offset:43520
    s_waitcnt lgkmcnt(6)
    v_mfma_f32_32x32x16_bf16 v[64:79], v[120:123], a[36:39], v[64:79]
    ds_read_b64_tr_b16 v[104:105], v145 offset:10240
    ds_read_b64_tr_b16 v[106:107], v145 offset:10752
    s_lshl_b32 s78, s61, 7
    s_add_u32 s78, s78, 0x924000
    buffer_load_dword v181, v147, s[4:7], s78 offen sc1
    s_waitcnt lgkmcnt(6)
    v_mfma_f32_32x32x16_bf16 v[80:95], v[124:127], a[36:39], v[80:95]
    ds_read_b64_tr_b16 v[108:109], v146 offset:5120
    ds_read_b64_tr_b16 v[110:111], v146 offset:5376
    s_waitcnt vmcnt(21) lgkmcnt(6)
    v_mfma_f32_32x32x16_bf16 v[32:47], v[96:99], a[40:43], v[32:47]
    ds_read_b64_tr_b16 v[112:113], v144 offset:11264
    ds_read_b64_tr_b16 v[114:115], v144 offset:11776
    buffer_load_dwordx4 a[24:27], v1, s[4:7], s79 offen offset:2048 sc1
    s_waitcnt lgkmcnt(6)
    v_mfma_f32_32x32x16_bf16 v[48:63], v[100:103], a[40:43], v[48:63]
    ds_read_b64_tr_b16 v[116:117], v144 offset:44032
    ds_read_b64_tr_b16 v[118:119], v144 offset:44544
    s_waitcnt lgkmcnt(6)
    v_mfma_f32_32x32x16_bf16 v[64:79], v[104:107], a[40:43], v[64:79]
    ds_read_b64_tr_b16 v[120:121], v145 offset:11264
    ds_read_b64_tr_b16 v[122:123], v145 offset:11776
    s_lshl_b32 s78, s61, 7
    s_add_u32 s78, s78, 0x928000
    buffer_load_dword v182, v147, s[4:7], s78 offen sc1
    s_waitcnt lgkmcnt(6)
    v_mfma_f32_32x32x16_bf16 v[80:95], v[108:111], a[40:43], v[80:95]
    ds_read_b64_tr_b16 v[124:125], v146 offset:5632
    ds_read_b64_tr_b16 v[126:127], v146 offset:5888
    s_waitcnt vmcnt(22) lgkmcnt(6)
    v_mfma_f32_32x32x16_bf16 v[32:47], v[112:115], a[44:47], v[32:47]
    ds_read_b64_tr_b16 v[96:97], v144 offset:12288
    ds_read_b64_tr_b16 v[98:99], v144 offset:12800
    buffer_load_dwordx4 a[28:31], v1, s[4:7], s79 offen offset:3072 sc1
    s_waitcnt lgkmcnt(6)
    v_mfma_f32_32x32x16_bf16 v[48:63], v[116:119], a[44:47], v[48:63]
    ds_read_b64_tr_b16 v[100:101], v144 offset:45056
    ds_read_b64_tr_b16 v[102:103], v144 offset:45568
    s_waitcnt lgkmcnt(6)
    v_mfma_f32_32x32x16_bf16 v[64:79], v[120:123], a[44:47], v[64:79]
    ds_read_b64_tr_b16 v[104:105], v145 offset:12288
    ds_read_b64_tr_b16 v[106:107], v145 offset:12800
    s_lshl_b32 s78, s61, 7
    s_add_u32 s78, s78, 0x92c000
    buffer_load_dword v183, v147, s[4:7], s78 offen sc1
    s_waitcnt lgkmcnt(6)
    v_mfma_f32_32x32x16_bf16 v[80:95], v[124:127], a[44:47], v[80:95]
    ds_read_b64_tr_b16 v[108:109], v146 offset:6144
    ds_read_b64_tr_b16 v[110:111], v146 offset:6400
    s_waitcnt vmcnt(23) lgkmcnt(6)
    v_mfma_f32_32x32x16_bf16 v[32:47], v[96:99], a[48:51], v[32:47]
    ds_read_b64_tr_b16 v[112:113], v144 offset:13312
    ds_read_b64_tr_b16 v[114:115], v144 offset:13824
    s_add_u32 s79, s79, 0x1000
    buffer_load_dwordx4 a[32:35], v1, s[4:7], s79 offen offset:0 sc1
    s_waitcnt lgkmcnt(6)
    v_mfma_f32_32x32x16_bf16 v[48:63], v[100:103], a[48:51], v[48:63]
    ds_read_b64_tr_b16 v[116:117], v144 offset:46080
    ds_read_b64_tr_b16 v[118:119], v144 offset:46592
    s_waitcnt lgkmcnt(6)
    v_mfma_f32_32x32x16_bf16 v[64:79], v[104:107], a[48:51], v[64:79]
    ds_read_b64_tr_b16 v[120:121], v145 offset:13312
    ds_read_b64_tr_b16 v[122:123], v145 offset:13824
    s_lshl_b32 s78, s61, 7
    s_add_u32 s78, s78, 0x930000
    buffer_load_dword v184, v147, s[4:7], s78 offen sc1
    s_waitcnt lgkmcnt(6)
    v_mfma_f32_32x32x16_bf16 v[80:95], v[108:111], a[48:51], v[80:95]
    ds_read_b64_tr_b16 v[124:125], v146 offset:6656
    ds_read_b64_tr_b16 v[126:127], v146 offset:6912
    s_waitcnt vmcnt(23) lgkmcnt(6)
    v_mfma_f32_32x32x16_bf16 v[32:47], v[112:115], a[52:55], v[32:47]
    ds_read_b64_tr_b16 v[96:97], v144 offset:14336
    ds_read_b64_tr_b16 v[98:99], v144 offset:14848
    buffer_load_dwordx4 a[36:39], v1, s[4:7], s79 offen offset:1024 sc1
    s_waitcnt lgkmcnt(6)
    v_mfma_f32_32x32x16_bf16 v[48:63], v[116:119], a[52:55], v[48:63]
    ds_read_b64_tr_b16 v[100:101], v144 offset:47104
    ds_read_b64_tr_b16 v[102:103], v144 offset:47616
    s_waitcnt lgkmcnt(6)
    v_mfma_f32_32x32x16_bf16 v[64:79], v[120:123], a[52:55], v[64:79]
    ds_read_b64_tr_b16 v[104:105], v145 offset:14336
    ds_read_b64_tr_b16 v[106:107], v145 offset:14848
    s_lshl_b32 s78, s61, 7
    s_add_u32 s78, s78, 0x934000
    buffer_load_dword v185, v147, s[4:7], s78 offen sc1
    s_waitcnt lgkmcnt(6)
    v_mfma_f32_32x32x16_bf16 v[80:95], v[124:127], a[52:55], v[80:95]
    ds_read_b64_tr_b16 v[108:109], v146 offset:7168
    ds_read_b64_tr_b16 v[110:111], v146 offset:7424
    s_waitcnt vmcnt(23) lgkmcnt(6)
    v_mfma_f32_32x32x16_bf16 v[32:47], v[96:99], a[56:59], v[32:47]
    ds_read_b64_tr_b16 v[112:113], v144 offset:15360
    ds_read_b64_tr_b16 v[114:115], v144 offset:15872
    buffer_load_dwordx4 a[40:43], v1, s[4:7], s79 offen offset:2048 sc1
    s_waitcnt lgkmcnt(6)
    v_mfma_f32_32x32x16_bf16 v[48:63], v[100:103], a[56:59], v[48:63]
    ds_read_b64_tr_b16 v[116:117], v144 offset:48128
    ds_read_b64_tr_b16 v[118:119], v144 offset:48640
    s_waitcnt lgkmcnt(6)
    v_mfma_f32_32x32x16_bf16 v[64:79], v[104:107], a[56:59], v[64:79]
    ds_read_b64_tr_b16 v[120:121], v145 offset:15360
    ds_read_b64_tr_b16 v[122:123], v145 offset:15872
    s_lshl_b32 s78, s61, 7
    s_add_u32 s78, s78, 0x938000
    buffer_load_dword v186, v147, s[4:7], s78 offen sc1
    s_waitcnt lgkmcnt(6)
    v_mfma_f32_32x32x16_bf16 v[80:95], v[108:111], a[56:59], v[80:95]
    ds_read_b64_tr_b16 v[124:125], v146 offset:7680
    ds_read_b64_tr_b16 v[126:127], v146 offset:7936
    s_waitcnt vmcnt(23) lgkmcnt(6)
    v_mfma_f32_32x32x16_bf16 v[32:47], v[112:115], a[60:63], v[32:47]
    ds_read_b64_tr_b16 v[96:97], v144 offset:16384
    ds_read_b64_tr_b16 v[98:99], v144 offset:16896
    buffer_load_dwordx4 a[44:47], v1, s[4:7], s79 offen offset:3072 sc1
    s_waitcnt lgkmcnt(6)
    v_mfma_f32_32x32x16_bf16 v[48:63], v[116:119], a[60:63], v[48:63]
    ds_read_b64_tr_b16 v[100:101], v144 offset:49152
    ds_read_b64_tr_b16 v[102:103], v144 offset:49664
    s_waitcnt lgkmcnt(6)
    v_mfma_f32_32x32x16_bf16 v[64:79], v[120:123], a[60:63], v[64:79]
    ds_read_b64_tr_b16 v[104:105], v145 offset:16384
    ds_read_b64_tr_b16 v[106:107], v145 offset:16896
    s_lshl_b32 s78, s61, 7
    s_add_u32 s78, s78, 0x93c000
    buffer_load_dword v187, v147, s[4:7], s78 offen sc1
    s_waitcnt lgkmcnt(6)
    v_mfma_f32_32x32x16_bf16 v[80:95], v[124:127], a[60:63], v[80:95]
    ds_read_b64_tr_b16 v[108:109], v146 offset:8192
    ds_read_b64_tr_b16 v[110:111], v146 offset:8448
    s_waitcnt vmcnt(23) lgkmcnt(6)
    v_mfma_f32_32x32x16_bf16 v[32:47], v[96:99], a[0:3], v[32:47]
    ds_read_b64_tr_b16 v[112:113], v144 offset:17408
    ds_read_b64_tr_b16 v[114:115], v144 offset:17920
    s_add_u32 s79, s79, 0x1000
    buffer_load_dwordx4 a[48:51], v1, s[4:7], s79 offen offset:0 sc1
    s_waitcnt lgkmcnt(6)
    v_mfma_f32_32x32x16_bf16 v[48:63], v[100:103], a[0:3], v[48:63]
    ds_read_b64_tr_b16 v[116:117], v144 offset:50176
    ds_read_b64_tr_b16 v[118:119], v144 offset:50688
    s_waitcnt lgkmcnt(6)
    v_mfma_f32_32x32x16_bf16 v[64:79], v[104:107], a[0:3], v[64:79]
    ds_read_b64_tr_b16 v[120:121], v145 offset:17408
    ds_read_b64_tr_b16 v[122:123], v145 offset:17920
    s_waitcnt lgkmcnt(6)
    v_mfma_f32_32x32x16_bf16 v[80:95], v[108:111], a[0:3], v[80:95]
    ds_read_b64_tr_b16 v[124:125], v146 offset:8704
    ds_read_b64_tr_b16 v[126:127], v146 offset:8960
    s_waitcnt vmcnt(22) lgkmcnt(6)
    v_mfma_f32_32x32x16_bf16 v[32:47], v[112:115], a[4:7], v[32:47]
    ds_read_b64_tr_b16 v[96:97], v144 offset:18432
    ds_read_b64_tr_b16 v[98:99], v144 offset:18944
    buffer_load_dwordx4 a[52:55], v1, s[4:7], s79 offen offset:1024 sc1
    s_waitcnt lgkmcnt(6)
    v_mfma_f32_32x32x16_bf16 v[48:63], v[116:119], a[4:7], v[48:63]
    ds_read_b64_tr_b16 v[100:101], v144 offset:51200
    ds_read_b64_tr_b16 v[102:103], v144 offset:51712
    s_waitcnt lgkmcnt(6)
    v_mfma_f32_32x32x16_bf16 v[64:79], v[120:123], a[4:7], v[64:79]
    ds_read_b64_tr_b16 v[104:105], v145 offset:18432
    ds_read_b64_tr_b16 v[106:107], v145 offset:18944
    s_waitcnt lgkmcnt(6)
    v_mfma_f32_32x32x16_bf16 v[80:95], v[124:127], a[4:7], v[80:95]
    ds_read_b64_tr_b16 v[108:109], v146 offset:9216
    ds_read_b64_tr_b16 v[110:111], v146 offset:9472
    s_waitcnt vmcnt(21) lgkmcnt(6)
    v_mfma_f32_32x32x16_bf16 v[32:47], v[96:99], a[8:11], v[32:47]
    ds_read_b64_tr_b16 v[112:113], v144 offset:19456
    ds_read_b64_tr_b16 v[114:115], v144 offset:19968
    buffer_load_dwordx4 a[56:59], v1, s[4:7], s79 offen offset:2048 sc1
    s_waitcnt lgkmcnt(6)
    v_mfma_f32_32x32x16_bf16 v[48:63], v[100:103], a[8:11], v[48:63]
    ds_read_b64_tr_b16 v[116:117], v144 offset:52224
    ds_read_b64_tr_b16 v[118:119], v144 offset:52736
    s_waitcnt lgkmcnt(6)
    v_mfma_f32_32x32x16_bf16 v[64:79], v[104:107], a[8:11], v[64:79]
    ds_read_b64_tr_b16 v[120:121], v145 offset:19456
    ds_read_b64_tr_b16 v[122:123], v145 offset:19968
    s_waitcnt lgkmcnt(6)
    v_mfma_f32_32x32x16_bf16 v[80:95], v[108:111], a[8:11], v[80:95]
    ds_read_b64_tr_b16 v[124:125], v146 offset:9728
    ds_read_b64_tr_b16 v[126:127], v146 offset:9984
    s_barrier
    s_waitcnt vmcnt(20) lgkmcnt(6)
    v_mfma_f32_32x32x16_bf16 v[32:47], v[112:115], a[12:15], v[32:47]
    ds_read_b64_tr_b16 v[96:97], v144 offset:20480
    ds_read_b64_tr_b16 v[98:99], v144 offset:20992
    buffer_load_dwordx4 a[60:63], v1, s[4:7], s79 offen offset:3072 sc1
    s_waitcnt lgkmcnt(6)
    v_mfma_f32_32x32x16_bf16 v[48:63], v[116:119], a[12:15], v[48:63]
    ds_read_b64_tr_b16 v[100:101], v144 offset:53248
    ds_read_b64_tr_b16 v[102:103], v144 offset:53760
    s_waitcnt lgkmcnt(6)
    v_mfma_f32_32x32x16_bf16 v[64:79], v[120:123], a[12:15], v[64:79]
    ds_read_b64_tr_b16 v[104:105], v145 offset:20480
    ds_read_b64_tr_b16 v[106:107], v145 offset:20992
    s_waitcnt lgkmcnt(6)
    v_mfma_f32_32x32x16_bf16 v[80:95], v[124:127], a[12:15], v[80:95]
    ds_read_b64_tr_b16 v[108:109], v146 offset:10240
    ds_read_b64_tr_b16 v[110:111], v146 offset:10496
    s_waitcnt vmcnt(19) lgkmcnt(6)
    v_mfma_f32_32x32x16_bf16 v[32:47], v[96:99], a[16:19], v[32:47]
    ds_read_b64_tr_b16 v[112:113], v144 offset:21504
    ds_read_b64_tr_b16 v[114:115], v144 offset:22016
    s_waitcnt lgkmcnt(6)
    v_mfma_f32_32x32x16_bf16 v[48:63], v[100:103], a[16:19], v[48:63]
    ds_read_b64_tr_b16 v[116:117], v144 offset:54272
    ds_read_b64_tr_b16 v[118:119], v144 offset:54784
    s_waitcnt lgkmcnt(6)
    v_mfma_f32_32x32x16_bf16 v[64:79], v[104:107], a[16:19], v[64:79]
    ds_read_b64_tr_b16 v[120:121], v145 offset:21504
    ds_read_b64_tr_b16 v[122:123], v145 offset:22016
    s_waitcnt lgkmcnt(6)
    v_mfma_f32_32x32x16_bf16 v[80:95], v[108:111], a[16:19], v[80:95]
    ds_read_b64_tr_b16 v[124:125], v146 offset:10752
    ds_read_b64_tr_b16 v[126:127], v146 offset:11008
    s_waitcnt vmcnt(17) lgkmcnt(6)
    v_mfma_f32_32x32x16_bf16 v[32:47], v[112:115], a[20:23], v[32:47]
    ds_read_b64_tr_b16 v[96:97], v144 offset:22528
    ds_read_b64_tr_b16 v[98:99], v144 offset:23040
    s_waitcnt lgkmcnt(6)
    v_mfma_f32_32x32x16_bf16 v[48:63], v[116:119], a[20:23], v[48:63]
    ds_read_b64_tr_b16 v[100:101], v144 offset:55296
    ds_read_b64_tr_b16 v[102:103], v144 offset:55808
    s_waitcnt lgkmcnt(6)
    v_mfma_f32_32x32x16_bf16 v[64:79], v[120:123], a[20:23], v[64:79]
    ds_read_b64_tr_b16 v[104:105], v145 offset:22528
    ds_read_b64_tr_b16 v[106:107], v145 offset:23040
    s_waitcnt lgkmcnt(6)
    v_mfma_f32_32x32x16_bf16 v[80:95], v[124:127], a[20:23], v[80:95]
    ds_read_b64_tr_b16 v[108:109], v146 offset:11264
    ds_read_b64_tr_b16 v[110:111], v146 offset:11520
    s_waitcnt vmcnt(15) lgkmcnt(6)
    v_mfma_f32_32x32x16_bf16 v[32:47], v[96:99], a[24:27], v[32:47]
    ds_read_b64_tr_b16 v[112:113], v144 offset:23552
    ds_read_b64_tr_b16 v[114:115], v144 offset:24064
    s_waitcnt lgkmcnt(6)
    v_mfma_f32_32x32x16_bf16 v[48:63], v[100:103], a[24:27], v[48:63]
    ds_read_b64_tr_b16 v[116:117], v144 offset:56320
    ds_read_b64_tr_b16 v[118:119], v144 offset:56832
    s_waitcnt lgkmcnt(6)
    v_mfma_f32_32x32x16_bf16 v[64:79], v[104:107], a[24:27], v[64:79]
    ds_read_b64_tr_b16 v[120:121], v145 offset:23552
    ds_read_b64_tr_b16 v[122:123], v145 offset:24064
    s_waitcnt lgkmcnt(6)
    v_mfma_f32_32x32x16_bf16 v[80:95], v[108:111], a[24:27], v[80:95]
    ds_read_b64_tr_b16 v[124:125], v146 offset:11776
    ds_read_b64_tr_b16 v[126:127], v146 offset:12032
    s_waitcnt vmcnt(13) lgkmcnt(6)
    v_mfma_f32_32x32x16_bf16 v[32:47], v[112:115], a[28:31], v[32:47]
    ds_read_b64_tr_b16 v[96:97], v144 offset:24576
    ds_read_b64_tr_b16 v[98:99], v144 offset:25088
    s_waitcnt lgkmcnt(6)
    v_mfma_f32_32x32x16_bf16 v[48:63], v[116:119], a[28:31], v[48:63]
    ds_read_b64_tr_b16 v[100:101], v144 offset:57344
    ds_read_b64_tr_b16 v[102:103], v144 offset:57856
    s_waitcnt lgkmcnt(6)
    v_mfma_f32_32x32x16_bf16 v[64:79], v[120:123], a[28:31], v[64:79]
    ds_read_b64_tr_b16 v[104:105], v145 offset:24576
    ds_read_b64_tr_b16 v[106:107], v145 offset:25088
    s_waitcnt lgkmcnt(6)
    v_mfma_f32_32x32x16_bf16 v[80:95], v[124:127], a[28:31], v[80:95]
    ds_read_b64_tr_b16 v[108:109], v146 offset:12288
    ds_read_b64_tr_b16 v[110:111], v146 offset:12544
    s_waitcnt vmcnt(4)
    s_waitcnt lgkmcnt(6)
    v_mfma_f32_32x32x16_bf16 v[32:47], v[96:99], a[32:35], v[32:47]
    ds_read_b64_tr_b16 v[112:113], v144 offset:25600
    ds_read_b64_tr_b16 v[114:115], v144 offset:26112
    v_add_f32 v172, v172, v180
    v_add_f32 v173, v173, v181
    s_waitcnt lgkmcnt(6)
    v_mfma_f32_32x32x16_bf16 v[48:63], v[100:103], a[32:35], v[48:63]
    ds_read_b64_tr_b16 v[116:117], v144 offset:58368
    ds_read_b64_tr_b16 v[118:119], v144 offset:58880
    v_add_f32 v174, v174, v182
    v_add_f32 v175, v175, v183
    s_waitcnt lgkmcnt(6)
    v_mfma_f32_32x32x16_bf16 v[64:79], v[104:107], a[32:35], v[64:79]
    ds_read_b64_tr_b16 v[120:121], v145 offset:25600
    ds_read_b64_tr_b16 v[122:123], v145 offset:26112
    v_add_f32 v176, v176, v184
    v_add_f32 v177, v177, v185
    s_waitcnt lgkmcnt(6)
    v_mfma_f32_32x32x16_bf16 v[80:95], v[108:111], a[32:35], v[80:95]
    ds_read_b64_tr_b16 v[124:125], v146 offset:12800
    ds_read_b64_tr_b16 v[126:127], v146 offset:13056
    v_add_f32 v178, v178, v186
    v_add_f32 v179, v179, v187
    s_waitcnt lgkmcnt(6)
    v_mfma_f32_32x32x16_bf16 v[32:47], v[112:115], a[36:39], v[32:47]
    ds_read_b64_tr_b16 v[96:97], v144 offset:26624
    ds_read_b64_tr_b16 v[98:99], v144 offset:27136
    v_add_f32 v172, v172, v176
    v_add_f32 v173, v173, v177
    s_waitcnt lgkmcnt(6)
    v_mfma_f32_32x32x16_bf16 v[48:63], v[116:119], a[36:39], v[48:63]
    ds_read_b64_tr_b16 v[100:101], v144 offset:59392
    ds_read_b64_tr_b16 v[102:103], v144 offset:59904
    v_add_f32 v174, v174, v178
    v_add_f32 v175, v175, v179
    s_waitcnt lgkmcnt(6)
    v_mfma_f32_32x32x16_bf16 v[64:79], v[120:123], a[36:39], v[64:79]
    ds_read_b64_tr_b16 v[104:105], v145 offset:26624
    ds_read_b64_tr_b16 v[106:107], v145 offset:27136
    v_add_f32 v172, v172, v174
    v_add_f32 v173, v173, v175
    s_waitcnt lgkmcnt(6)
    v_mfma_f32_32x32x16_bf16 v[80:95], v[124:127], a[36:39], v[80:95]
    ds_read_b64_tr_b16 v[108:109], v146 offset:13312
    ds_read_b64_tr_b16 v[110:111], v146 offset:13568
    v_add_f32 v172, v172, v173
    v_mov_b32 v173, v172
    s_waitcnt lgkmcnt(6)
    v_mfma_f32_32x32x16_bf16 v[32:47], v[96:99], a[40:43], v[32:47]
    ds_read_b64_tr_b16 v[112:113], v144 offset:27648
    ds_read_b64_tr_b16 v[114:115], v144 offset:28160
    v_lshlrev_b32 v28, 4, v23
    v_add_u32 v149, 161280, v28
    s_waitcnt lgkmcnt(6)
    v_mfma_f32_32x32x16_bf16 v[48:63], v[100:103], a[40:43], v[48:63]
    ds_read_b64_tr_b16 v[116:117], v144 offset:60416
    ds_read_b64_tr_b16 v[118:119], v144 offset:60928
    v_permlane32_swap_b32 v172, v173
    s_mul_i32 s67, s61, 114688
    s_waitcnt lgkmcnt(6)
    v_mfma_f32_32x32x16_bf16 v[64:79], v[104:107], a[40:43], v[64:79]
    ds_read_b64_tr_b16 v[120:121], v145 offset:27648
    ds_read_b64_tr_b16 v[122:123], v145 offset:28160
    v_mul_f32 v174, s89, v172
    s_mul_i32 s64, s59, 7168
    s_waitcnt lgkmcnt(6)
    v_mfma_f32_32x32x16_bf16 v[80:95], v[108:111], a[40:43], v[80:95]
    ds_read_b64_tr_b16 v[124:125], v146 offset:13824
    ds_read_b64_tr_b16 v[126:127], v146 offset:14080
    v_mul_f32 v26, s89, v173
    s_add_u32 s67, s67, s64
    s_waitcnt lgkmcnt(6)
    v_mfma_f32_32x32x16_bf16 v[32:47], v[112:115], a[44:47], v[32:47]
    ds_read_b64_tr_b16 v[96:97], v144 offset:28672
    ds_read_b64_tr_b16 v[98:99], v144 offset:29184
    v_fma_f32 v26, -v174, v174, v26
    s_add_u32 s67, s67, 0xa00000
    s_waitcnt lgkmcnt(6)
    v_mfma_f32_32x32x16_bf16 v[48:63], v[116:119], a[44:47], v[48:63]
    ds_read_b64_tr_b16 v[100:101], v144 offset:61440
    ds_read_b64_tr_b16 v[102:103], v144 offset:61952
    v_max_f32 v26, 0, v26
    s_and_b32 s65, s59, 1
    s_waitcnt lgkmcnt(6)
    v_mfma_f32_32x32x16_bf16 v[64:79], v[120:123], a[44:47], v[64:79]
    ds_read_b64_tr_b16 v[104:105], v145 offset:28672
    ds_read_b64_tr_b16 v[106:107], v145 offset:29184
    v_add_f32 v26, s85, v26
    s_lshl_b32 s68, s65, 10
    s_waitcnt lgkmcnt(6)
    v_mfma_f32_32x32x16_bf16 v[80:95], v[124:127], a[44:47], v[80:95]
    ds_read_b64_tr_b16 v[108:109], v146 offset:14336
    ds_read_b64_tr_b16 v[110:111], v146 offset:14592
    v_rsq_f32 v27, v26
    s_add_u32 s68, s68, s67
    s_waitcnt vmcnt(3) lgkmcnt(6)
    v_mfma_f32_32x32x16_bf16 v[32:47], v[96:99], a[48:51], v[32:47]
    ds_read_b64_tr_b16 v[112:113], v144 offset:29696
    ds_read_b64_tr_b16 v[114:115], v144 offset:30208
    v_sub_f32 v132, 0, v174
    s_xor_b32 s65, s65, 1
    s_waitcnt lgkmcnt(6)
    v_mfma_f32_32x32x16_bf16 v[48:63], v[100:103], a[48:51], v[48:63]
    ds_read_b64_tr_b16 v[116:117], v144 offset:62464
    ds_read_b64_tr_b16 v[118:119], v144 offset:62976
    v_mul_f32 v128, s87, v27
    s_mul_i32 s65, s65, 6144
    s_waitcnt lgkmcnt(6)
    v_mfma_f32_32x32x16_bf16 v[64:79], v[104:107], a[48:51], v[64:79]
    ds_read_b64_tr_b16 v[120:121], v145 offset:29696
    ds_read_b64_tr_b16 v[122:123], v145 offset:30208
    v_mul_f32 v129, v27, v27
    s_add_u32 s69, s67, s65
    s_waitcnt lgkmcnt(6)
    v_mfma_f32_32x32x16_bf16 v[80:95], v[108:111], a[48:51], v[80:95]
    ds_read_b64_tr_b16 v[124:125], v146 offset:14848
    ds_read_b64_tr_b16 v[126:127], v146 offset:15104
    v_mul_f32 v129, v129, v27
    v_mul_f32 v129, s88, v129
    s_waitcnt vmcnt(2) lgkmcnt(6)
    v_mfma_f32_32x32x16_bf16 v[32:47], v[112:115], a[52:55], v[32:47]
    ds_read_b64_tr_b16 v[96:97], v144 offset:30720
    ds_read_b64_tr_b16 v[98:99], v144 offset:31232
    v_rcp_f32 v130, v27
    s_waitcnt lgkmcnt(6)
    v_mfma_f32_32x32x16_bf16 v[48:63], v[116:119], a[52:55], v[48:63]
    ds_read_b64_tr_b16 v[100:101], v144 offset:63488
    ds_read_b64_tr_b16 v[102:103], v144 offset:64000
    s_waitcnt lgkmcnt(6)
    v_mfma_f32_32x32x16_bf16 v[64:79], v[120:123], a[52:55], v[64:79]
    ds_read_b64_tr_b16 v[104:105], v145 offset:30720
    ds_read_b64_tr_b16 v[106:107], v145 offset:31232
    s_waitcnt lgkmcnt(6)
    v_mfma_f32_32x32x16_bf16 v[80:95], v[124:127], a[52:55], v[80:95]
    ds_read_b64_tr_b16 v[108:109], v146 offset:15360
    ds_read_b64_tr_b16 v[110:111], v146 offset:15616
    s_waitcnt vmcnt(1) lgkmcnt(6)
    v_mfma_f32_32x32x16_bf16 v[32:47], v[96:99], a[56:59], v[32:47]
    ds_read_b64_tr_b16 v[112:113], v144 offset:31744
    ds_read_b64_tr_b16 v[114:115], v144 offset:32256
    s_waitcnt lgkmcnt(6)
    v_mfma_f32_32x32x16_bf16 v[48:63], v[100:103], a[56:59], v[48:63]
    ds_read_b64_tr_b16 v[116:117], v144 offset:64512
    ds_read_b64_tr_b16 v[118:119], v144 offset:65024
    s_waitcnt lgkmcnt(6)
    v_mfma_f32_32x32x16_bf16 v[64:79], v[104:107], a[56:59], v[64:79]
    ds_read_b64_tr_b16 v[120:121], v145 offset:31744
    ds_read_b64_tr_b16 v[122:123], v145 offset:32256
    s_waitcnt lgkmcnt(6)
    v_mfma_f32_32x32x16_bf16 v[80:95], v[108:111], a[56:59], v[80:95]
    ds_read_b64_tr_b16 v[124:125], v146 offset:15872
    ds_read_b64_tr_b16 v[126:127], v146 offset:16128
    s_waitcnt vmcnt(0) lgkmcnt(6)
    v_mfma_f32_32x32x16_bf16 v[32:47], v[112:115], a[60:63], v[32:47]
    s_waitcnt lgkmcnt(4)
    v_mfma_f32_32x32x16_bf16 v[48:63], v[116:119], a[60:63], v[48:63]
    s_waitcnt lgkmcnt(2)
    v_mfma_f32_32x32x16_bf16 v[64:79], v[120:123], a[60:63], v[64:79]
    s_waitcnt lgkmcnt(0)
    v_mfma_f32_32x32x16_bf16 v[80:95], v[124:127], a[60:63], v[80:95]
    s_barrier
    ds_read_b128 v[96:99], v149 offset:0
    ds_read_b128 v[100:103], v149 offset:32
    ds_read_b128 v[104:107], v149 offset:64
    ds_read_b128 v[108:111], v149 offset:96
    ds_read_b128 v[112:115], v149 offset:128
    ds_read_b128 v[116:119], v149 offset:160
    ds_read_b128 v[120:123], v149 offset:192
    ds_read_b128 v[124:127], v149 offset:224
    s_waitcnt lgkmcnt(4)
    v_pk_fma_f32 v[32:33], v[96:97], v[132:133], v[32:33] op_sel_hi:[1,0,1]
    v_pk_fma_f32 v[34:35], v[98:99], v[132:133], v[34:35] op_sel_hi:[1,0,1]
    v_pk_fma_f32 v[36:37], v[100:101], v[132:133], v[36:37] op_sel_hi:[1,0,1]
    v_pk_fma_f32 v[38:39], v[102:103], v[132:133], v[38:39] op_sel_hi:[1,0,1]
    v_pk_fma_f32 v[40:41], v[104:105], v[132:133], v[40:41] op_sel_hi:[1,0,1]
    v_pk_fma_f32 v[42:43], v[106:107], v[132:133], v[42:43] op_sel_hi:[1,0,1]
    v_pk_fma_f32 v[44:45], v[108:109], v[132:133], v[44:45] op_sel_hi:[1,0,1]
    v_pk_fma_f32 v[46:47], v[110:111], v[132:133], v[46:47] op_sel_hi:[1,0,1]
    v_pk_mul_f32 v[176:177], v[32:33], v[32:33]
    v_pk_mul_f32 v[180:181], v[34:35], v[34:35]
    v_pk_mul_f32 v[184:185], v[36:37], v[36:37]
    v_pk_mul_f32 v[188:189], v[38:39], v[38:39]
    v_pk_fma_f32 v[176:177], v[176:177], v[128:129], v[128:129] op_sel:[0,1,0] op_sel_hi:[1,1,0]
    v_pk_fma_f32 v[180:181], v[180:181], v[128:129], v[128:129] op_sel:[0,1,0] op_sel_hi:[1,1,0]
    v_pk_fma_f32 v[184:185], v[184:185], v[128:129], v[128:129] op_sel:[0,1,0] op_sel_hi:[1,1,0]
    v_pk_fma_f32 v[188:189], v[188:189], v[128:129], v[128:129] op_sel:[0,1,0] op_sel_hi:[1,1,0]
    v_pk_mul_f32 v[176:177], v[176:177], v[32:33]
    v_pk_mul_f32 v[180:181], v[180:181], v[34:35]
    v_pk_mul_f32 v[184:185], v[184:185], v[36:37]
    v_pk_mul_f32 v[188:189], v[188:189], v[38:39]
    v_exp_f32 v178, v176
    v_exp_f32 v179, v177
    v_exp_f32 v182, v180
    v_exp_f32 v183, v181
    v_exp_f32 v186, v184
    v_exp_f32 v187, v185
    v_exp_f32 v190, v188
    v_exp_f32 v191, v189
    v_pk_fma_f32 v[176:177], v[178:179], v[130:131], v[130:131] op_sel_hi:[1,0,0]
    v_pk_fma_f32 v[180:181], v[182:183], v[130:131], v[130:131] op_sel_hi:[1,0,0]
    v_pk_fma_f32 v[184:185], v[186:187], v[130:131], v[130:131] op_sel_hi:[1,0,0]
    v_pk_fma_f32 v[188:189], v[190:191], v[130:131], v[130:131] op_sel_hi:[1,0,0]
    v_rcp_f32 v178, v176
    v_rcp_f32 v179, v177
    v_rcp_f32 v182, v180
    v_rcp_f32 v183, v181
    v_rcp_f32 v186, v184
    v_rcp_f32 v187, v185
    v_rcp_f32 v190, v188
    v_rcp_f32 v191, v189
    v_pk_mul_f32 v[176:177], v[178:179], v[32:33]
    v_pk_mul_f32 v[180:181], v[182:183], v[34:35]
    v_pk_mul_f32 v[184:185], v[186:187], v[36:37]
    v_pk_mul_f32 v[188:189], v[190:191], v[38:39]
    v_cvt_pk_bf16_f32 v152, v176, v177
    v_cvt_pk_bf16_f32 v153, v180, v181
    v_cvt_pk_bf16_f32 v154, v184, v185
    v_cvt_pk_bf16_f32 v155, v188, v189
    v_pk_mul_f32 v[176:177], v[40:41], v[40:41]
    v_pk_mul_f32 v[180:181], v[42:43], v[42:43]
    v_pk_mul_f32 v[184:185], v[44:45], v[44:45]
    v_pk_mul_f32 v[188:189], v[46:47], v[46:47]
    v_pk_fma_f32 v[176:177], v[176:177], v[128:129], v[128:129] op_sel:[0,1,0] op_sel_hi:[1,1,0]
    v_pk_fma_f32 v[180:181], v[180:181], v[128:129], v[128:129] op_sel:[0,1,0] op_sel_hi:[1,1,0]
    v_pk_fma_f32 v[184:185], v[184:185], v[128:129], v[128:129] op_sel:[0,1,0] op_sel_hi:[1,1,0]
    v_pk_fma_f32 v[188:189], v[188:189], v[128:129], v[128:129] op_sel:[0,1,0] op_sel_hi:[1,1,0]
    v_pk_mul_f32 v[176:177], v[176:177], v[40:41]
    v_pk_mul_f32 v[180:181], v[180:181], v[42:43]
    v_pk_mul_f32 v[184:185], v[184:185], v[44:45]
    v_pk_mul_f32 v[188:189], v[188:189], v[46:47]
    v_exp_f32 v178, v176
    v_exp_f32 v179, v177
    v_exp_f32 v182, v180
    v_exp_f32 v183, v181
    v_exp_f32 v186, v184
    v_exp_f32 v187, v185
    v_exp_f32 v190, v188
    v_exp_f32 v191, v189
    v_pk_fma_f32 v[176:177], v[178:179], v[130:131], v[130:131] op_sel_hi:[1,0,0]
    v_pk_fma_f32 v[180:181], v[182:183], v[130:131], v[130:131] op_sel_hi:[1,0,0]
    v_pk_fma_f32 v[184:185], v[186:187], v[130:131], v[130:131] op_sel_hi:[1,0,0]
    v_pk_fma_f32 v[188:189], v[190:191], v[130:131], v[130:131] op_sel_hi:[1,0,0]
    v_rcp_f32 v178, v176
    v_rcp_f32 v179, v177
    v_rcp_f32 v182, v180
    v_rcp_f32 v183, v181
    v_rcp_f32 v186, v184
    v_rcp_f32 v187, v185
    v_rcp_f32 v190, v188
    v_rcp_f32 v191, v189
    v_pk_mul_f32 v[176:177], v[178:179], v[40:41]
    v_pk_mul_f32 v[180:181], v[182:183], v[42:43]
    v_pk_mul_f32 v[184:185], v[186:187], v[44:45]
    v_pk_mul_f32 v[188:189], v[190:191], v[46:47]
    v_cvt_pk_bf16_f32 v156, v176, v177
    v_cvt_pk_bf16_f32 v157, v180, v181
    v_cvt_pk_bf16_f32 v158, v184, v185
    v_cvt_pk_bf16_f32 v159, v188, v189
    s_add_u32 s64, s68, 0
    buffer_store_dwordx4 v[152:155], v1, s[4:7], s64 offen sc1
    buffer_store_dwordx4 v[156:159], v1, s[4:7], s64 offen offset:1024 sc1
    s_barrier
    ds_read_b128 v[96:99], v149 offset:256
    ds_read_b128 v[100:103], v149 offset:288
    ds_read_b128 v[104:107], v149 offset:320
    ds_read_b128 v[108:111], v149 offset:352
    s_waitcnt lgkmcnt(4)
    v_pk_fma_f32 v[48:49], v[112:113], v[132:133], v[48:49] op_sel_hi:[1,0,1]
    v_pk_fma_f32 v[50:51], v[114:115], v[132:133], v[50:51] op_sel_hi:[1,0,1]
    v_pk_fma_f32 v[52:53], v[116:117], v[132:133], v[52:53] op_sel_hi:[1,0,1]
    v_pk_fma_f32 v[54:55], v[118:119], v[132:133], v[54:55] op_sel_hi:[1,0,1]
    v_pk_fma_f32 v[56:57], v[120:121], v[132:133], v[56:57] op_sel_hi:[1,0,1]
    v_pk_fma_f32 v[58:59], v[122:123], v[132:133], v[58:59] op_sel_hi:[1,0,1]
    v_pk_fma_f32 v[60:61], v[124:125], v[132:133], v[60:61] op_sel_hi:[1,0,1]
    v_pk_fma_f32 v[62:63], v[126:127], v[132:133], v[62:63] op_sel_hi:[1,0,1]
    v_pk_mul_f32 v[176:177], v[48:49], v[48:49]
    v_pk_mul_f32 v[180:181], v[50:51], v[50:51]
    v_pk_mul_f32 v[184:185], v[52:53], v[52:53]
    v_pk_mul_f32 v[188:189], v[54:55], v[54:55]
    v_pk_fma_f32 v[176:177], v[176:177], v[128:129], v[128:129] op_sel:[0,1,0] op_sel_hi:[1,1,0]
    v_pk_fma_f32 v[180:181], v[180:181], v[128:129], v[128:129] op_sel:[0,1,0] op_sel_hi:[1,1,0]
    v_pk_fma_f32 v[184:185], v[184:185], v[128:129], v[128:129] op_sel:[0,1,0] op_sel_hi:[1,1,0]
    v_pk_fma_f32 v[188:189], v[188:189], v[128:129], v[128:129] op_sel:[0,1,0] op_sel_hi:[1,1,0]
    v_pk_mul_f32 v[176:177], v[176:177], v[48:49]
    v_pk_mul_f32 v[180:181], v[180:181], v[50:51]
    v_pk_mul_f32 v[184:185], v[184:185], v[52:53]
    v_pk_mul_f32 v[188:189], v[188:189], v[54:55]
    v_exp_f32 v178, v176
    v_exp_f32 v179, v177
    v_exp_f32 v182, v180
    v_exp_f32 v183, v181
    v_exp_f32 v186, v184
    v_exp_f32 v187, v185
    v_exp_f32 v190, v188
    v_exp_f32 v191, v189
    v_pk_fma_f32 v[176:177], v[178:179], v[130:131], v[130:131] op_sel_hi:[1,0,0]
    v_pk_fma_f32 v[180:181], v[182:183], v[130:131], v[130:131] op_sel_hi:[1,0,0]
    v_pk_fma_f32 v[184:185], v[186:187], v[130:131], v[130:131] op_sel_hi:[1,0,0]
    v_pk_fma_f32 v[188:189], v[190:191], v[130:131], v[130:131] op_sel_hi:[1,0,0]
    v_rcp_f32 v178, v176
    v_rcp_f32 v179, v177
    v_rcp_f32 v182, v180
    v_rcp_f32 v183, v181
    v_rcp_f32 v186, v184
    v_rcp_f32 v187, v185
    v_rcp_f32 v190, v188
    v_rcp_f32 v191, v189
    v_pk_mul_f32 v[176:177], v[178:179], v[48:49]
    v_pk_mul_f32 v[180:181], v[182:183], v[50:51]
    v_pk_mul_f32 v[184:185], v[186:187], v[52:53]
    v_pk_mul_f32 v[188:189], v[190:191], v[54:55]
    v_cvt_pk_bf16_f32 v160, v176, v177
    v_cvt_pk_bf16_f32 v161, v180, v181
    v_cvt_pk_bf16_f32 v162, v184, v185
    v_cvt_pk_bf16_f32 v163, v188, v189
    v_pk_mul_f32 v[176:177], v[56:57], v[56:57]
    v_pk_mul_f32 v[180:181], v[58:59], v[58:59]
    v_pk_mul_f32 v[184:185], v[60:61], v[60:61]
    v_pk_mul_f32 v[188:189], v[62:63], v[62:63]
    v_pk_fma_f32 v[176:177], v[176:177], v[128:129], v[128:129] op_sel:[0,1,0] op_sel_hi:[1,1,0]
    v_pk_fma_f32 v[180:181], v[180:181], v[128:129], v[128:129] op_sel:[0,1,0] op_sel_hi:[1,1,0]
    v_pk_fma_f32 v[184:185], v[184:185], v[128:129], v[128:129] op_sel:[0,1,0] op_sel_hi:[1,1,0]
    v_pk_fma_f32 v[188:189], v[188:189], v[128:129], v[128:129] op_sel:[0,1,0] op_sel_hi:[1,1,0]
    v_pk_mul_f32 v[176:177], v[176:177], v[56:57]
    v_pk_mul_f32 v[180:181], v[180:181], v[58:59]
    v_pk_mul_f32 v[184:185], v[184:185], v[60:61]
    v_pk_mul_f32 v[188:189], v[188:189], v[62:63]
    v_exp_f32 v178, v176
    v_exp_f32 v179, v177
    v_exp_f32 v182, v180
    v_exp_f32 v183, v181
    v_exp_f32 v186, v184
    v_exp_f32 v187, v185
    v_exp_f32 v190, v188
    v_exp_f32 v191, v189
    v_pk_fma_f32 v[176:177], v[178:179], v[130:131], v[130:131] op_sel_hi:[1,0,0]
    v_pk_fma_f32 v[180:181], v[182:183], v[130:131], v[130:131] op_sel_hi:[1,0,0]
    v_pk_fma_f32 v[184:185], v[186:187], v[130:131], v[130:131] op_sel_hi:[1,0,0]
    v_pk_fma_f32 v[188:189], v[190:191], v[130:131], v[130:131] op_sel_hi:[1,0,0]
    v_rcp_f32 v178, v176
    v_rcp_f32 v179, v177
    v_rcp_f32 v182, v180
    v_rcp_f32 v183, v181
    v_rcp_f32 v186, v184
    v_rcp_f32 v187, v185
    v_rcp_f32 v190, v188
    v_rcp_f32 v191, v189
    v_pk_mul_f32 v[176:177], v[178:179], v[56:57]
    v_pk_mul_f32 v[180:181], v[182:183], v[58:59]
    v_pk_mul_f32 v[184:185], v[186:187], v[60:61]
    v_pk_mul_f32 v[188:189], v[190:191], v[62:63]
    v_cvt_pk_bf16_f32 v164, v176, v177
    v_cvt_pk_bf16_f32 v165, v180, v181
    v_cvt_pk_bf16_f32 v166, v184, v185
    v_cvt_pk_bf16_f32 v167, v188, v189
    s_add_u32 s64, s68, 2048
    buffer_store_dwordx4 v[160:163], v1, s[4:7], s64 offen sc1
    buffer_store_dwordx4 v[164:167], v1, s[4:7], s64 offen offset:1024 sc1
    ds_read_b128 v[112:115], v149 offset:384
    ds_read_b128 v[116:119], v149 offset:416
    s_waitcnt lgkmcnt(2)
    v_pk_fma_f32 v[64:65], v[96:97], v[132:133], v[64:65] op_sel_hi:[1,0,1]
    v_pk_fma_f32 v[66:67], v[98:99], v[132:133], v[66:67] op_sel_hi:[1,0,1]
    v_pk_fma_f32 v[68:69], v[100:101], v[132:133], v[68:69] op_sel_hi:[1,0,1]
    v_pk_fma_f32 v[70:71], v[102:103], v[132:133], v[70:71] op_sel_hi:[1,0,1]
    v_pk_fma_f32 v[72:73], v[104:105], v[132:133], v[72:73] op_sel_hi:[1,0,1]
    v_pk_fma_f32 v[74:75], v[106:107], v[132:133], v[74:75] op_sel_hi:[1,0,1]
    v_pk_fma_f32 v[76:77], v[108:109], v[132:133], v[76:77] op_sel_hi:[1,0,1]
    v_pk_fma_f32 v[78:79], v[110:111], v[132:133], v[78:79] op_sel_hi:[1,0,1]
    v_pk_mul_f32 v[176:177], v[64:65], v[64:65]
    v_pk_mul_f32 v[180:181], v[66:67], v[66:67]
    v_pk_mul_f32 v[184:185], v[68:69], v[68:69]
    v_pk_mul_f32 v[188:189], v[70:71], v[70:71]
    v_pk_fma_f32 v[176:177], v[176:177], v[128:129], v[128:129] op_sel:[0,1,0] op_sel_hi:[1,1,0]
    v_pk_fma_f32 v[180:181], v[180:181], v[128:129], v[128:129] op_sel:[0,1,0] op_sel_hi:[1,1,0]
    v_pk_fma_f32 v[184:185], v[184:185], v[128:129], v[128:129] op_sel:[0,1,0] op_sel_hi:[1,1,0]
    v_pk_fma_f32 v[188:189], v[188:189], v[128:129], v[128:129] op_sel:[0,1,0] op_sel_hi:[1,1,0]
    v_pk_mul_f32 v[176:177], v[176:177], v[64:65]
    v_pk_mul_f32 v[180:181], v[180:181], v[66:67]
    v_pk_mul_f32 v[184:185], v[184:185], v[68:69]
    v_pk_mul_f32 v[188:189], v[188:189], v[70:71]
    v_exp_f32 v178, v176
    v_exp_f32 v179, v177
    v_exp_f32 v182, v180
    v_exp_f32 v183, v181
    v_exp_f32 v186, v184
    v_exp_f32 v187, v185
    v_exp_f32 v190, v188
    v_exp_f32 v191, v189
    v_pk_fma_f32 v[176:177], v[178:179], v[130:131], v[130:131] op_sel_hi:[1,0,0]
    v_pk_fma_f32 v[180:181], v[182:183], v[130:131], v[130:131] op_sel_hi:[1,0,0]
    v_pk_fma_f32 v[184:185], v[186:187], v[130:131], v[130:131] op_sel_hi:[1,0,0]
    v_pk_fma_f32 v[188:189], v[190:191], v[130:131], v[130:131] op_sel_hi:[1,0,0]
    v_rcp_f32 v178, v176
    v_rcp_f32 v179, v177
    v_rcp_f32 v182, v180
    v_rcp_f32 v183, v181
    v_rcp_f32 v186, v184
    v_rcp_f32 v187, v185
    v_rcp_f32 v190, v188
    v_rcp_f32 v191, v189
    v_pk_mul_f32 v[176:177], v[178:179], v[64:65]
    v_pk_mul_f32 v[180:181], v[182:183], v[66:67]
    v_pk_mul_f32 v[184:185], v[186:187], v[68:69]
    v_pk_mul_f32 v[188:189], v[190:191], v[70:71]
    v_cvt_pk_bf16_f32 v152, v176, v177
    v_cvt_pk_bf16_f32 v153, v180, v181
    v_cvt_pk_bf16_f32 v154, v184, v185
    v_cvt_pk_bf16_f32 v155, v188, v189
    v_pk_mul_f32 v[176:177], v[72:73], v[72:73]
    v_pk_mul_f32 v[180:181], v[74:75], v[74:75]
    v_pk_mul_f32 v[184:185], v[76:77], v[76:77]
    v_pk_mul_f32 v[188:189], v[78:79], v[78:79]
    v_pk_fma_f32 v[176:177], v[176:177], v[128:129], v[128:129] op_sel:[0,1,0] op_sel_hi:[1,1,0]
    v_pk_fma_f32 v[180:181], v[180:181], v[128:129], v[128:129] op_sel:[0,1,0] op_sel_hi:[1,1,0]
    v_pk_fma_f32 v[184:185], v[184:185], v[128:129], v[128:129] op_sel:[0,1,0] op_sel_hi:[1,1,0]
    v_pk_fma_f32 v[188:189], v[188:189], v[128:129], v[128:129] op_sel:[0,1,0] op_sel_hi:[1,1,0]
    v_pk_mul_f32 v[176:177], v[176:177], v[72:73]
    v_pk_mul_f32 v[180:181], v[180:181], v[74:75]
    v_pk_mul_f32 v[184:185], v[184:185], v[76:77]
    v_pk_mul_f32 v[188:189], v[188:189], v[78:79]
    v_exp_f32 v178, v176
    v_exp_f32 v179, v177
    v_exp_f32 v182, v180
    v_exp_f32 v183, v181
    v_exp_f32 v186, v184
    v_exp_f32 v187, v185
    v_exp_f32 v190, v188
    v_exp_f32 v191, v189
    v_pk_fma_f32 v[176:177], v[178:179], v[130:131], v[130:131] op_sel_hi:[1,0,0]
    v_pk_fma_f32 v[180:181], v[182:183], v[130:131], v[130:131] op_sel_hi:[1,0,0]
    v_pk_fma_f32 v[184:185], v[186:187], v[130:131], v[130:131] op_sel_hi:[1,0,0]
    v_pk_fma_f32 v[188:189], v[190:191], v[130:131], v[130:131] op_sel_hi:[1,0,0]
    v_rcp_f32 v178, v176
    v_rcp_f32 v179, v177
    v_rcp_f32 v182, v180
    v_rcp_f32 v183, v181
    v_rcp_f32 v186, v184
    v_rcp_f32 v187, v185
    v_rcp_f32 v190, v188
    v_rcp_f32 v191, v189
    v_pk_mul_f32 v[176:177], v[178:179], v[72:73]
    v_pk_mul_f32 v[180:181], v[182:183], v[74:75]
    v_pk_mul_f32 v[184:185], v[186:187], v[76:77]
    v_pk_mul_f32 v[188:189], v[190:191], v[78:79]
    v_cvt_pk_bf16_f32 v156, v176, v177
    v_cvt_pk_bf16_f32 v157, v180, v181
    v_cvt_pk_bf16_f32 v158, v184, v185
    v_cvt_pk_bf16_f32 v159, v188, v189
    s_add_u32 s64, s68, 4096
    buffer_store_dwordx4 v[152:155], v1, s[4:7], s64 offen sc1
    buffer_store_dwordx4 v[156:159], v1, s[4:7], s64 offen offset:1024 sc1
    s_waitcnt lgkmcnt(0)
    v_pk_fma_f32 v[80:81], v[112:113], v[132:133], v[80:81] op_sel_hi:[1,0,1]
    v_pk_fma_f32 v[82:83], v[114:115], v[132:133], v[82:83] op_sel_hi:[1,0,1]
    v_pk_fma_f32 v[84:85], v[116:117], v[132:133], v[84:85] op_sel_hi:[1,0,1]
    v_pk_fma_f32 v[86:87], v[118:119], v[132:133], v[86:87] op_sel_hi:[1,0,1]
    v_pk_mul_f32 v[176:177], v[80:81], v[80:81]
    v_pk_mul_f32 v[180:181], v[82:83], v[82:83]
    v_pk_mul_f32 v[184:185], v[84:85], v[84:85]
    v_pk_mul_f32 v[188:189], v[86:87], v[86:87]
    v_pk_fma_f32 v[176:177], v[176:177], v[128:129], v[128:129] op_sel:[0,1,0] op_sel_hi:[1,1,0]
    v_pk_fma_f32 v[180:181], v[180:181], v[128:129], v[128:129] op_sel:[0,1,0] op_sel_hi:[1,1,0]
    v_pk_fma_f32 v[184:185], v[184:185], v[128:129], v[128:129] op_sel:[0,1,0] op_sel_hi:[1,1,0]
    v_pk_fma_f32 v[188:189], v[188:189], v[128:129], v[128:129] op_sel:[0,1,0] op_sel_hi:[1,1,0]
    v_pk_mul_f32 v[176:177], v[176:177], v[80:81]
    v_pk_mul_f32 v[180:181], v[180:181], v[82:83]
    v_pk_mul_f32 v[184:185], v[184:185], v[84:85]
    v_pk_mul_f32 v[188:189], v[188:189], v[86:87]
    v_exp_f32 v178, v176
    v_exp_f32 v179, v177
    v_exp_f32 v182, v180
    v_exp_f32 v183, v181
    v_exp_f32 v186, v184
    v_exp_f32 v187, v185
    v_exp_f32 v190, v188
    v_exp_f32 v191, v189
    v_pk_fma_f32 v[176:177], v[178:179], v[130:131], v[130:131] op_sel_hi:[1,0,0]
    v_pk_fma_f32 v[180:181], v[182:183], v[130:131], v[130:131] op_sel_hi:[1,0,0]
    v_pk_fma_f32 v[184:185], v[186:187], v[130:131], v[130:131] op_sel_hi:[1,0,0]
    v_pk_fma_f32 v[188:189], v[190:191], v[130:131], v[130:131] op_sel_hi:[1,0,0]
    v_rcp_f32 v178, v176
    v_rcp_f32 v179, v177
    v_rcp_f32 v182, v180
    v_rcp_f32 v183, v181
    v_rcp_f32 v186, v184
    v_rcp_f32 v187, v185
    v_rcp_f32 v190, v188
    v_rcp_f32 v191, v189
    v_pk_mul_f32 v[176:177], v[178:179], v[80:81]
    v_pk_mul_f32 v[180:181], v[182:183], v[82:83]
    v_pk_mul_f32 v[184:185], v[186:187], v[84:85]
    v_pk_mul_f32 v[188:189], v[190:191], v[86:87]
    v_cvt_pk_bf16_f32 v160, v176, v177
    v_cvt_pk_bf16_f32 v161, v180, v181
    v_cvt_pk_bf16_f32 v162, v184, v185
    v_cvt_pk_bf16_f32 v163, v188, v189
    buffer_store_dwordx4 v[160:163], v1, s[4:7], s69 offen sc1
    s_lshl_b32 s64, s55, 4
    s_sub_u32 s64, 74904, s64
    v_lshl_add_u32 v160, v0, 3, s64
    s_mul_i32 s64, s55, 2624
    s_lshl_b32 s65, s56, 5
    s_add_u32 s64, s64, s65
    s_add_u32 s64, s64, 91424
    v_bfe_u32 v26, v0, 2, 2
    v_mul_u32_u24 v26, 5312, v26
    v_and_b32 v27, 3, v0
    v_lshrrev_b32 v28, 4, v0
    v_sub_u32 v27, v27, v28
    v_lshl_add_u32 v26, v27, 3, v26
    v_add_u32 v161, s64, v26
    s_waitcnt vmcnt(0)
    s_barrier
    s_lshl_b32 s65, s58, 4
    s_add_u32 s65, s65, s59
    s_cmp_lg_u32 s54, 0
    s_cbranch_scc1 L_noflag_11
    s_lshl_b32 s64, s65, 7
    s_add_u32 s64, s64, 69632
    v_mov_b32 v26, s57
    v_mov_b32 v27, s64
    s_mov_b64 exec, 1
    buffer_store_dword v26, v27, s[4:7], 0 offen sc1
    s_mov_b64 exec, -1
L_noflag_11:
    ds_read_b64_tr_b16 v[64:65], v160 offset:8
    ds_read_b64_tr_b16 v[66:67], v160 offset:520
    ds_read_b64_tr_b16 v[96:97], v161 offset:32
    ds_read_b64_tr_b16 v[98:99], v161 offset:0
    ds_read_b64_tr_b16 v[100:101], v161 offset:96
    ds_read_b64_tr_b16 v[102:103], v161 offset:64
    ds_read_b64_tr_b16 v[104:105], v161 offset:160
    ds_read_b64_tr_b16 v[106:107], v161 offset:128
    ds_read_b64_tr_b16 v[108:109], v161 offset:224
    ds_read_b64_tr_b16 v[110:111], v161 offset:192
    ds_read_b64_tr_b16 v[68:69], v160 offset:1032
    ds_read_b64_tr_b16 v[70:71], v160 offset:1544
    ds_read_b64_tr_b16 v[72:73], v160 offset:2056
    ds_read_b64_tr_b16 v[74:75], v160 offset:2568
    ds_read_b64_tr_b16 v[76:77], v160 offset:3080
    ds_read_b64_tr_b16 v[78:79], v160 offset:3592
    s_waitcnt lgkmcnt(12)
    v_mfma_f32_16x16x32_bf16 v[32:35], v[64:67], v[96:99], 0
    ds_read_b64_tr_b16 v[80:81], v160 offset:4136
    ds_read_b64_tr_b16 v[82:83], v160 offset:4648
    s_waitcnt lgkmcnt(12)
    v_mfma_f32_16x16x32_bf16 v[36:39], v[64:67], v[100:103], 0
    ds_read_b64_tr_b16 v[112:113], v161 offset:360
    ds_read_b64_tr_b16 v[114:115], v161 offset:328
    s_waitcnt lgkmcnt(12)
    v_mfma_f32_16x16x32_bf16 v[40:43], v[64:67], v[104:107], 0
    ds_read_b64_tr_b16 v[116:117], v161 offset:424
    ds_read_b64_tr_b16 v[118:119], v161 offset:392
    s_waitcnt lgkmcnt(12)
    v_mfma_f32_16x16x32_bf16 v[44:47], v[64:67], v[108:111], 0
    ds_read_b64_tr_b16 v[120:121], v161 offset:488
    ds_read_b64_tr_b16 v[122:123], v161 offset:456
    s_waitcnt lgkmcnt(12)
    v_mfma_f32_16x16x32_bf16 v[36:39], v[68:71], v[96:99], v[36:39]
    ds_read_b64_tr_b16 v[124:125], v161 offset:552
    ds_read_b64_tr_b16 v[126:127], v161 offset:520
    v_mfma_f32_16x16x32_bf16 v[40:43], v[68:71], v[100:103], v[40:43]
    ds_read_b64_tr_b16 v[84:85], v160 offset:5160
    ds_read_b64_tr_b16 v[86:87], v160 offset:5672
    v_mfma_f32_16x16x32_bf16 v[44:47], v[68:71], v[104:107], v[44:47]
    ds_read_b64_tr_b16 v[88:89], v160 offset:6184
    s_waitcnt lgkmcnt(15)
    v_mfma_f32_16x16x32_bf16 v[40:43], v[72:75], v[96:99], v[40:43]
    ds_read_b64_tr_b16 v[90:91], v160 offset:6696
    v_mfma_f32_16x16x32_bf16 v[44:47], v[72:75], v[100:103], v[44:47]
    ds_read_b64_tr_b16 v[92:93], v160 offset:7208
    s_waitcnt lgkmcnt(15)
    v_mfma_f32_16x16x32_bf16 v[44:47], v[76:79], v[96:99], v[44:47]
    ds_read_b64_tr_b16 v[94:95], v160 offset:7720
    s_waitcnt lgkmcnt(12)
    v_mfma_f32_16x16x32_bf16 v[32:35], v[80:83], v[112:115], v[32:35]
    ds_read_b64_tr_b16 v[64:65], v160 offset:8264
    ds_read_b64_tr_b16 v[66:67], v160 offset:8776
    s_waitcnt lgkmcnt(12)
    v_mfma_f32_16x16x32_bf16 v[36:39], v[80:83], v[116:119], v[36:39]
    ds_read_b64_tr_b16 v[96:97], v161 offset:688
    ds_read_b64_tr_b16 v[98:99], v161 offset:656
    s_waitcnt lgkmcnt(12)
    v_mfma_f32_16x16x32_bf16 v[40:43], v[80:83], v[120:123], v[40:43]
    ds_read_b64_tr_b16 v[100:101], v161 offset:752
    ds_read_b64_tr_b16 v[102:103], v161 offset:720
    s_waitcnt lgkmcnt(12)
    v_mfma_f32_16x16x32_bf16 v[44:47], v[80:83], v[124:127], v[44:47]
    ds_read_b64_tr_b16 v[104:105], v161 offset:816
    ds_read_b64_tr_b16 v[106:107], v161 offset:784
    s_waitcnt lgkmcnt(12)
    v_mfma_f32_16x16x32_bf16 v[36:39], v[84:87], v[112:115], v[36:39]
    ds_read_b64_tr_b16 v[108:109], v161 offset:880
    ds_read_b64_tr_b16 v[110:111], v161 offset:848
    v_mfma_f32_16x16x32_bf16 v[40:43], v[84:87], v[116:119], v[40:43]
    ds_read_b64_tr_b16 v[68:69], v160 offset:9288
    ds_read_b64_tr_b16 v[70:71], v160 offset:9800
    v_mfma_f32_16x16x32_bf16 v[44:47], v[84:87], v[120:123], v[44:47]
    ds_read_b64_tr_b16 v[72:73], v160 offset:10312
    s_waitcnt lgkmcnt(15)
    v_mfma_f32_16x16x32_bf16 v[40:43], v[88:91], v[112:115], v[40:43]
    ds_read_b64_tr_b16 v[74:75], v160 offset:10824
    v_mfma_f32_16x16x32_bf16 v[44:47], v[88:91], v[116:119], v[44:47]
    ds_read_b64_tr_b16 v[76:77], v160 offset:11336
    s_waitcnt lgkmcnt(15)
    v_mfma_f32_16x16x32_bf16 v[44:47], v[92:95], v[112:115], v[44:47]
    ds_read_b64_tr_b16 v[78:79], v160 offset:11848
    s_waitcnt lgkmcnt(12)
    v_mfma_f32_16x16x32_bf16 v[32:35], v[64:67], v[96:99], v[32:35]
    ds_read_b64_tr_b16 v[80:81], v160 offset:12392
    ds_read_b64_tr_b16 v[82:83], v160 offset:12904
    s_waitcnt lgkmcnt(12)
    v_mfma_f32_16x16x32_bf16 v[36:39], v[64:67], v[100:103], v[36:39]
    ds_read_b64_tr_b16 v[112:113], v161 offset:1016
    ds_read_b64_tr_b16 v[114:115], v161 offset:984
    s_waitcnt lgkmcnt(12)
    v_mfma_f32_16x16x32_bf16 v[40:43], v[64:67], v[104:107], v[40:43]
    ds_read_b64_tr_b16 v[116:117], v161 offset:1080
    ds_read_b64_tr_b16 v[118:119], v161 offset:1048
    s_waitcnt lgkmcnt(12)
    v_mfma_f32_16x16x32_bf16 v[44:47], v[64:67], v[108:111], v[44:47]
    ds_read_b64_tr_b16 v[120:121], v161 offset:1144
    ds_read_b64_tr_b16 v[122:123], v161 offset:1112
    s_waitcnt lgkmcnt(12)
    v_mfma_f32_16x16x32_bf16 v[36:39], v[68:71], v[96:99], v[36:39]
    ds_read_b64_tr_b16 v[124:125], v161 offset:1208
    ds_read_b64_tr_b16 v[126:127], v161 offset:1176
    v_mfma_f32_16x16x32_bf16 v[40:43], v[68:71], v[100:103], v[40:43]
    ds_read_b64_tr_b16 v[84:85], v160 offset:13416
    ds_read_b64_tr_b16 v[86:87], v160 offset:13928
    v_mfma_f32_16x16x32_bf16 v[44:47], v[68:71], v[104:107], v[44:47]
    ds_read_b64_tr_b16 v[88:89], v160 offset:14440
    s_waitcnt lgkmcnt(15)
    v_mfma_f32_16x16x32_bf16 v[40:43], v[72:75], v[96:99], v[40:43]
    ds_read_b64_tr_b16 v[90:91], v160 offset:14952
    v_mfma_f32_16x16x32_bf16 v[44:47], v[72:75], v[100:103], v[44:47]
    ds_read_b64_tr_b16 v[92:93], v160 offset:15464
    s_waitcnt lgkmcnt(15)
    v_mfma_f32_16x16x32_bf16 v[44:47], v[76:79], v[96:99], v[44:47]
    ds_read_b64_tr_b16 v[94:95], v160 offset:15976
    s_waitcnt lgkmcnt(12)
    v_mfma_f32_16x16x32_bf16 v[32:35], v[80:83], v[112:115], v[32:35]
    ds_read_b64_tr_b16 v[64:65], v160 offset:0
    ds_read_b64_tr_b16 v[66:67], v160 offset:512
    s_waitcnt lgkmcnt(12)
    v_mfma_f32_16x16x32_bf16 v[36:39], v[80:83], v[116:119], v[36:39]
    ds_read_b64_tr_b16 v[96:97], v161 offset:1344
    ds_read_b64_tr_b16 v[98:99], v161 offset:1312
    s_waitcnt lgkmcnt(12)
    v_mfma_f32_16x16x32_bf16 v[40:43], v[80:83], v[120:123], v[40:43]
    ds_read_b64_tr_b16 v[100:101], v161 offset:1408
    ds_read_b64_tr_b16 v[102:103], v161 offset:1376
    s_waitcnt lgkmcnt(12)
    v_mfma_f32_16x16x32_bf16 v[44:47], v[80:83], v[124:127], v[44:47]
    ds_read_b64_tr_b16 v[104:105], v161 offset:1472
    ds_read_b64_tr_b16 v[106:107], v161 offset:1440
    s_waitcnt lgkmcnt(12)
    v_mfma_f32_16x16x32_bf16 v[36:39], v[84:87], v[112:115], v[36:39]
    ds_read_b64_tr_b16 v[108:109], v161 offset:1536
    ds_read_b64_tr_b16 v[110:111], v161 offset:1504
    v_mfma_f32_16x16x32_bf16 v[40:43], v[84:87], v[116:119], v[40:43]
    ds_read_b64_tr_b16 v[68:69], v160 offset:1024
    ds_read_b64_tr_b16 v[70:71], v160 offset:1536
    v_mfma_f32_16x16x32_bf16 v[44:47], v[84:87], v[120:123], v[44:47]
    ds_read_b64_tr_b16 v[72:73], v160 offset:2048
    s_waitcnt lgkmcnt(15)
    v_mfma_f32_16x16x32_bf16 v[40:43], v[88:91], v[112:115], v[40:43]
    ds_read_b64_tr_b16 v[74:75], v160 offset:2560
    v_mfma_f32_16x16x32_bf16 v[44:47], v[88:91], v[116:119], v[44:47]
    ds_read_b64_tr_b16 v[76:77], v160 offset:3072
    s_waitcnt lgkmcnt(15)
    v_mfma_f32_16x16x32_bf16 v[44:47], v[92:95], v[112:115], v[44:47]
    ds_read_b64_tr_b16 v[78:79], v160 offset:3584
    s_waitcnt lgkmcnt(12)
    v_mfma_f32_16x16x32_bf16 v[32:35], v[64:67], v[96:99], v[32:35]
    ds_read_b64_tr_b16 v[80:81], v160 offset:4128
    ds_read_b64_tr_b16 v[82:83], v160 offset:4640
    s_waitcnt lgkmcnt(12)
    v_mfma_f32_16x16x32_bf16 v[36:39], v[64:67], v[100:103], v[36:39]
    ds_read_b64_tr_b16 v[112:113], v161 offset:1672
    ds_read_b64_tr_b16 v[114:115], v161 offset:1640
    s_waitcnt lgkmcnt(12)
    v_mfma_f32_16x16x32_bf16 v[40:43], v[64:67], v[104:107], v[40:43]
    ds_read_b64_tr_b16 v[116:117], v161 offset:1736
    ds_read_b64_tr_b16 v[118:119], v161 offset:1704
    s_waitcnt lgkmcnt(12)
    v_mfma_f32_16x16x32_bf16 v[44:47], v[64:67], v[108:111], v[44:47]
    ds_read_b64_tr_b16 v[120:121], v161 offset:1800
    ds_read_b64_tr_b16 v[122:123], v161 offset:1768
    s_waitcnt lgkmcnt(12)
    v_mfma_f32_16x16x32_bf16 v[36:39], v[68:71], v[96:99], v[36:39]
    ds_read_b64_tr_b16 v[124:125], v161 offset:1864
    ds_read_b64_tr_b16 v[126:127], v161 offset:1832
    v_mfma_f32_16x16x32_bf16 v[40:43], v[68:71], v[100:103], v[40:43]
    ds_read_b64_tr_b16 v[84:85], v160 offset:5152
    ds_read_b64_tr_b16 v[86:87], v160 offset:5664
    v_mfma_f32_16x16x32_bf16 v[44:47], v[68:71], v[104:107], v[44:47]
    ds_read_b64_tr_b16 v[88:89], v160 offset:6176
    s_waitcnt lgkmcnt(15)
    v_mfma_f32_16x16x32_bf16 v[40:43], v[72:75], v[96:99], v[40:43]
    ds_read_b64_tr_b16 v[90:91], v160 offset:6688
    v_mfma_f32_16x16x32_bf16 v[44:47], v[72:75], v[100:103], v[44:47]
    ds_read_b64_tr_b16 v[92:93], v160 offset:7200
    s_waitcnt lgkmcnt(15)
    v_mfma_f32_16x16x32_bf16 v[44:47], v[76:79], v[96:99], v[44:47]
    ds_read_b64_tr_b16 v[94:95], v160 offset:7712
    s_waitcnt lgkmcnt(12)
    v_mfma_f32_16x16x32_bf16 v[32:35], v[80:83], v[112:115], v[32:35]
    ds_read_b64_tr_b16 v[64:65], v160 offset:8256
    ds_read_b64_tr_b16 v[66:67], v160 offset:8768
    s_waitcnt lgkmcnt(12)
    v_mfma_f32_16x16x32_bf16 v[36:39], v[80:83], v[116:119], v[36:39]
    ds_read_b64_tr_b16 v[96:97], v161 offset:2000
    ds_read_b64_tr_b16 v[98:99], v161 offset:1968
    s_waitcnt lgkmcnt(12)
    v_mfma_f32_16x16x32_bf16 v[40:43], v[80:83], v[120:123], v[40:43]
    ds_read_b64_tr_b16 v[100:101], v161 offset:2064
    ds_read_b64_tr_b16 v[102:103], v161 offset:2032
    s_waitcnt lgkmcnt(12)
    v_mfma_f32_16x16x32_bf16 v[44:47], v[80:83], v[124:127], v[44:47]
    ds_read_b64_tr_b16 v[104:105], v161 offset:2128
    ds_read_b64_tr_b16 v[106:107], v161 offset:2096
    s_waitcnt lgkmcnt(12)
    v_mfma_f32_16x16x32_bf16 v[36:39], v[84:87], v[112:115], v[36:39]
    ds_read_b64_tr_b16 v[108:109], v161 offset:2192
    ds_read_b64_tr_b16 v[110:111], v161 offset:2160
    v_mfma_f32_16x16x32_bf16 v[40:43], v[84:87], v[116:119], v[40:43]
    ds_read_b64_tr_b16 v[68:69], v160 offset:9280
    ds_read_b64_tr_b16 v[70:71], v160 offset:9792
    v_mfma_f32_16x16x32_bf16 v[44:47], v[84:87], v[120:123], v[44:47]
    ds_read_b64_tr_b16 v[72:73], v160 offset:10304
    s_waitcnt lgkmcnt(15)
    v_mfma_f32_16x16x32_bf16 v[40:43], v[88:91], v[112:115], v[40:43]
    ds_read_b64_tr_b16 v[74:75], v160 offset:10816
    v_mfma_f32_16x16x32_bf16 v[44:47], v[88:91], v[116:119], v[44:47]
    ds_read_b64_tr_b16 v[76:77], v160 offset:11328
    s_waitcnt lgkmcnt(15)
    v_mfma_f32_16x16x32_bf16 v[44:47], v[92:95], v[112:115], v[44:47]
    ds_read_b64_tr_b16 v[78:79], v160 offset:11840
    s_lshr_b32 s64, s52, 1
    s_lshl_b32 s64, s64, 4
    s_lshl_b32 s65, s56, 3
    s_add_u32 s64, s64, s65
    v_and_b32 v28, 7, v0
    v_add_u32 v28, s64, v28
    v_lshlrev_b32 v171, 7, v28
    v_add_u32 v171, 69632, v171
    buffer_load_dword v170, v171, s[4:7], 0 offen sc1
    s_waitcnt lgkmcnt(12)
    v_mfma_f32_16x16x32_bf16 v[32:35], v[64:67], v[96:99], v[32:35]
    ds_read_b64_tr_b16 v[80:81], v160 offset:12384
    ds_read_b64_tr_b16 v[82:83], v160 offset:12896
    s_waitcnt lgkmcnt(12)
    v_mfma_f32_16x16x32_bf16 v[36:39], v[64:67], v[100:103], v[36:39]
    ds_read_b64_tr_b16 v[112:113], v161 offset:2328
    ds_read_b64_tr_b16 v[114:115], v161 offset:2296
    s_waitcnt lgkmcnt(12)
    v_mfma_f32_16x16x32_bf16 v[40:43], v[64:67], v[104:107], v[40:43]
    ds_read_b64_tr_b16 v[116:117], v161 offset:2392
    ds_read_b64_tr_b16 v[118:119], v161 offset:2360
    s_waitcnt lgkmcnt(12)
    v_mfma_f32_16x16x32_bf16 v[44:47], v[64:67], v[108:111], v[44:47]
    ds_read_b64_tr_b16 v[120:121], v161 offset:2456
    ds_read_b64_tr_b16 v[122:123], v161 offset:2424
    s_waitcnt lgkmcnt(12)
    v_mfma_f32_16x16x32_bf16 v[36:39], v[68:71], v[96:99], v[36:39]
    ds_read_b64_tr_b16 v[124:125], v161 offset:2520
    ds_read_b64_tr_b16 v[126:127], v161 offset:2488
    v_mfma_f32_16x16x32_bf16 v[40:43], v[68:71], v[100:103], v[40:43]
    ds_read_b64_tr_b16 v[84:85], v160 offset:13408
    ds_read_b64_tr_b16 v[86:87], v160 offset:13920
    v_mfma_f32_16x16x32_bf16 v[44:47], v[68:71], v[104:107], v[44:47]
    ds_read_b64_tr_b16 v[88:89], v160 offset:14432
    s_waitcnt lgkmcnt(15)
    v_mfma_f32_16x16x32_bf16 v[40:43], v[72:75], v[96:99], v[40:43]
    ds_read_b64_tr_b16 v[90:91], v160 offset:14944
    v_mfma_f32_16x16x32_bf16 v[44:47], v[72:75], v[100:103], v[44:47]
    ds_read_b64_tr_b16 v[92:93], v160 offset:15456
    s_waitcnt lgkmcnt(15)
    v_mfma_f32_16x16x32_bf16 v[44:47], v[76:79], v[96:99], v[44:47]
    ds_read_b64_tr_b16 v[94:95], v160 offset:15968
    s_waitcnt lgkmcnt(12)
    v_mfma_f32_16x16x32_bf16 v[32:35], v[80:83], v[112:115], v[32:35]
    s_waitcnt lgkmcnt(10)
    v_mfma_f32_16x16x32_bf16 v[36:39], v[80:83], v[116:119], v[36:39]
    s_waitcnt lgkmcnt(8)
    v_mfma_f32_16x16x32_bf16 v[40:43], v[80:83], v[120:123], v[40:43]
    s_waitcnt lgkmcnt(6)
    v_mfma_f32_16x16x32_bf16 v[44:47], v[80:83], v[124:127], v[44:47]
    s_waitcnt lgkmcnt(4)
    v_mfma_f32_16x16x32_bf16 v[36:39], v[84:87], v[112:115], v[36:39]
    v_mfma_f32_16x16x32_bf16 v[40:43], v[84:87], v[116:119], v[40:43]
    v_mfma_f32_16x16x32_bf16 v[44:47], v[84:87], v[120:123], v[44:47]
    s_waitcnt lgkmcnt(2)
    v_mfma_f32_16x16x32_bf16 v[40:43], v[88:91], v[112:115], v[40:43]
    v_mfma_f32_16x16x32_bf16 v[44:47], v[88:91], v[116:119], v[44:47]
    s_waitcnt lgkmcnt(0)
    v_mfma_f32_16x16x32_bf16 v[44:47], v[92:95], v[112:115], v[44:47]
    s_mul_i32 s79, s60, 114688
    s_mul_i32 s65, s56, 57344
    s_add_u32 s79, s79, s65
    s_add_u32 s79, s79, 0xa00000
    s_waitcnt vmcnt(0)
    v_cmp_ne_u32 vcc, s57, v170
    s_nop 0
    s_cmp_eq_u64 vcc, 0
    s_cbranch_scc1 L_polled_13
    s_mov_b32 s86, 0x40000
L_poll_12:
    buffer_load_dword v170, v171, s[4:7], 0 offen sc1
    s_waitcnt vmcnt(0)
    v_cmp_ne_u32 vcc, s57, v170
    s_nop 0
    s_cmp_eq_u64 vcc, 0
    s_cbranch_scc1 L_polled_13
    s_sub_u32 s86, s86, 1
    s_cmp_lg_u32 s86, 0
    s_cbranch_scc1 L_poll_12
    v_mov_b32 v26, 0
    v_mov_b32 v27, 261
    s_mov_b64 exec, 1
    global_store_dword v26, v27, s[30:31]
    s_mov_b64 exec, -1
L_polled_13:
    s_add_u32 s76, s79, 0
    buffer_load_dwordx4 a[0:3], v1, s[4:7], s76 offen offset:0 sc1
    buffer_load_dwordx4 a[4:7], v1, s[4:7], s76 offen offset:1024 sc1
    buffer_load_dwordx4 a[8:11], v1, s[4:7], s76 offen offset:2048 sc1
    buffer_load_dwordx4 a[12:15], v1, s[4:7], s76 offen offset:3072 sc1
    s_add_u32 s76, s76, 0x1000
    buffer_load_dwordx4 a[16:19], v1, s[4:7], s76 offen offset:0 sc1
    buffer_load_dwordx4 a[20:23], v1, s[4:7], s76 offen offset:1024 sc1
    buffer_load_dwordx4 a[24:27], v1, s[4:7], s76 offen offset:2048 sc1
    s_add_u32 s76, s79, 7168
    buffer_load_dwordx4 a[28:31], v1, s[4:7], s76 offen offset:0 sc1
    buffer_load_dwordx4 a[32:35], v1, s[4:7], s76 offen offset:1024 sc1
    buffer_load_dwordx4 a[36:39], v1, s[4:7], s76 offen offset:2048 sc1
    buffer_load_dwordx4 a[40:43], v1, s[4:7], s76 offen offset:3072 sc1
    s_add_u32 s76, s76, 0x1000
    buffer_load_dwordx4 a[44:47], v1, s[4:7], s76 offen offset:0 sc1
    buffer_load_dwordx4 a[48:51], v1, s[4:7], s76 offen offset:1024 sc1
    buffer_load_dwordx4 a[52:55], v1, s[4:7], s76 offen offset:2048 sc1
    s_barrier
    s_lshl_b32 s64, s54, 11
    s_add_u32 s64, s64, 74880
    v_add_u32 v26, s64, v1
    s_cmp_lg_u32 s55, 0
    s_cbranch_scc1 L_cvhi_14
    ds_write_b128 v26, v[40:43] offset:0
    ds_write_b128 v26, v[44:47] offset:1024
    s_branch L_cvsent_15
L_cvhi_14:
    ds_write_b128 v26, v[32:35] offset:0
    ds_write_b128 v26, v[36:39] offset:1024
L_cvsent_15:
    s_lshl_b32 s68, s55, 2
    s_add_u32 s68, s68, s56
    s_lshl_b32 s68, s68, 9
    s_add_u32 s64, s68, 70784
    v_and_b32 v27, 15, v0
    v_lshlrev_b32 v27, 5, v27
    v_lshrrev_b32 v28, 4, v0
    v_lshl_add_u32 v27, v28, 3, v27
    v_add_u32 v27, s64, v27
    ds_read_b64 v[100:101], v27 offset:0
    ds_read_b64 v[102:103], v27 offset:1024
    s_waitcnt lgkmcnt(0)
    s_barrier
    s_xor_b32 s64, s54, 2
    s_lshl_b32 s64, s64, 11
    s_add_u32 s64, s64, 74880
    v_add_u32 v26, s64, v1
    ds_read_b128 v[72:75], v26 offset:0
    ds_read_b128 v[76:79], v26 offset:1024
    v_lshlrev_b32 v104, 16, v100
    v_and_b32 v105, s81, v100
    v_lshlrev_b32 v106, 16, v101
    v_and_b32 v107, s81, v101
    v_lshlrev_b32 v108, 16, v102
    v_and_b32 v109, s81, v102
    v_lshlrev_b32 v110, 16, v103
    v_and_b32 v111, s81, v103
    v_mov_b32 v112, s63
    v_lshrrev_b32 v26, 4, v0
    v_and_b32 v27, 1, v26
    v_lshlrev_b32 v27, 10, v27
    v_lshrrev_b32 v26, 1, v26
    v_lshl_add_u32 v27, v26, 4, v27
    v_and_b32 v26, 15, v0
    v_lshl_add_u32 v27, v26, 5, v27
    v_add_u32 v27, s68, v27
    s_lshl_b32 s64, s2, 13
    s_add_u32 s64, s64, 0x301000
    s_waitcnt lgkmcnt(0)
    s_cmp_lg_u32 s55, 0
    s_cbranch_scc1 L_cvhi_16
    v_pk_add_f32 v[64:65], v[32:33], v[72:73]
    v_pk_add_f32 v[66:67], v[34:35], v[74:75]
    v_pk_add_f32 v[68:69], v[36:37], v[76:77]
    v_pk_add_f32 v[70:71], v[38:39], v[78:79]
    s_branch L_cvsum_17
L_cvhi_16:
    v_pk_add_f32 v[64:65], v[40:41], v[72:73]
    v_pk_add_f32 v[66:67], v[42:43], v[74:75]
    v_pk_add_f32 v[68:69], v[44:45], v[76:77]
    v_pk_add_f32 v[70:71], v[46:47], v[78:79]
L_cvsum_17:
    v_pk_fma_f32 v[64:65], v[104:105], v[112:113], v[64:65] op_sel_hi:[1,0,1]
    v_pk_fma_f32 v[66:67], v[106:107], v[112:113], v[66:67] op_sel_hi:[1,0,1]
    v_pk_fma_f32 v[68:69], v[108:109], v[112:113], v[68:69] op_sel_hi:[1,0,1]
    v_pk_fma_f32 v[70:71], v[110:111], v[112:113], v[70:71] op_sel_hi:[1,0,1]
    v_cvt_pk_bf16_f32 v116, v64, v65
    v_cvt_pk_bf16_f32 v117, v66, v67
    v_cvt_pk_bf16_f32 v118, v68, v69
    v_cvt_pk_bf16_f32 v119, v70, v71
    s_nop 0
    v_permlane16_swap_b32 v116, v118
    v_permlane16_swap_b32 v117, v119
    buffer_store_dwordx4 v[116:119], v27, s[4:7], s64 offen sc1
    s_add_u32 s76, s79, 14336
    buffer_load_dwordx4 a[56:59], v1, s[4:7], s76 offen offset:0 sc1
    buffer_load_dwordx4 a[60:63], v1, s[4:7], s76 offen offset:1024 sc1
    buffer_load_dwordx4 v[64:67], v1, s[4:7], s76 offen offset:2048 sc1
    buffer_load_dwordx4 v[68:71], v1, s[4:7], s76 offen offset:3072 sc1
    s_add_u32 s76, s76, 0x1000
    buffer_load_dwordx4 v[72:75], v1, s[4:7], s76 offen offset:0 sc1
    buffer_load_dwordx4 v[76:79], v1, s[4:7], s76 offen offset:1024 sc1
    s_mul_i32 s64, s56, 3072
    s_add_u32 s64, s64, 0
    v_add_u32 v128, s64, v2
    s_mul_i32 s64, s56, 1024
    s_add_u32 s64, s64, 1024
    v_add_u32 v131, s64, v2
    v_add_u32 v129, 65536, v128
    v_add_u32 v132, 65536, v131
    v_add_u32 v130, 131072, v128
    v_add_u32 v133, 131072, v131
    s_barrier
    ds_read_b64_tr_b16 v[96:97], v129 offset:49152
    ds_read_b64_tr_b16 v[98:99], v129 offset:49664
    ds_read_b64_tr_b16 v[104:105], v132 offset:49152
    ds_read_b64_tr_b16 v[106:107], v132 offset:49664
    s_waitcnt vmcnt(20) lgkmcnt(2)
    v_mfma_f32_32x32x16_bf16 v[32:47], v[96:99], a[0:3], 0
    ds_read_b64_tr_b16 v[100:101], v129 offset:53248
    ds_read_b64_tr_b16 v[102:103], v129 offset:53760
    s_waitcnt lgkmcnt(2)
    v_mfma_f32_32x32x16_bf16 v[48:63], v[104:107], a[0:3], 0
    ds_read_b64_tr_b16 v[108:109], v132 offset:53248
    ds_read_b64_tr_b16 v[110:111], v132 offset:53760
    s_waitcnt vmcnt(19) lgkmcnt(2)
    v_mfma_f32_32x32x16_bf16 v[32:47], v[100:103], a[4:7], v[32:47]
    ds_read_b64_tr_b16 v[96:97], v129 offset:57344
    ds_read_b64_tr_b16 v[98:99], v129 offset:57856
    buffer_load_dwordx4 v[80:83], v1, s[4:7], s76 offen offset:2048 sc1
    s_waitcnt lgkmcnt(2)
    v_mfma_f32_32x32x16_bf16 v[48:63], v[108:111], a[4:7], v[48:63]
    ds_read_b64_tr_b16 v[104:105], v132 offset:57344
    ds_read_b64_tr_b16 v[106:107], v132 offset:57856
    s_waitcnt vmcnt(19) lgkmcnt(2)
    v_mfma_f32_32x32x16_bf16 v[32:47], v[96:99], a[8:11], v[32:47]
    ds_read_b64_tr_b16 v[100:101], v129 offset:61440
    ds_read_b64_tr_b16 v[102:103], v129 offset:61952
    s_add_u32 s76, s79, 21504
    buffer_load_dwordx4 v[84:87], v1, s[4:7], s76 offen offset:0 sc1
    s_waitcnt lgkmcnt(2)
    v_mfma_f32_32x32x16_bf16 v[48:63], v[104:107], a[8:11], v[48:63]
    ds_read_b64_tr_b16 v[108:109], v132 offset:61440
    ds_read_b64_tr_b16 v[110:111], v132 offset:61952
    v_lshlrev_b32 v112, 16, v4
    v_and_b32 v113, s81, v4
    v_lshlrev_b32 v148, 16, v12
    s_waitcnt vmcnt(19) lgkmcnt(2)
    v_mfma_f32_32x32x16_bf16 v[32:47], v[100:103], a[12:15], v[32:47]
    ds_read_b64_tr_b16 v[96:97], v130 offset:0
    ds_read_b64_tr_b16 v[98:99], v130 offset:512
    buffer_load_dwordx4 v[88:91], v1, s[4:7], s76 offen offset:1024 sc1
    s_waitcnt lgkmcnt(2)
    v_mfma_f32_32x32x16_bf16 v[48:63], v[108:111], a[12:15], v[48:63]
    ds_read_b64_tr_b16 v[104:105], v133 offset:0
    ds_read_b64_tr_b16 v[106:107], v133 offset:512
    v_and_b32 v149, s81, v12
    v_lshlrev_b32 v114, 16, v5
    v_and_b32 v115, s81, v5
    s_waitcnt vmcnt(19) lgkmcnt(2)
    v_mfma_f32_32x32x16_bf16 v[32:47], v[96:99], a[16:19], v[32:47]
    ds_read_b64_tr_b16 v[100:101], v130 offset:4096
    ds_read_b64_tr_b16 v[102:103], v130 offset:4608
    buffer_load_dwordx4 v[92:95], v1, s[4:7], s76 offen offset:2048 sc1
    s_waitcnt lgkmcnt(2)
    v_mfma_f32_32x32x16_bf16 v[48:63], v[104:107], a[16:19], v[48:63]
    ds_read_b64_tr_b16 v[108:109], v133 offset:4096
    ds_read_b64_tr_b16 v[110:111], v133 offset:4608
    v_lshlrev_b32 v150, 16, v13
    v_and_b32 v151, s81, v13
    v_lshlrev_b32 v116, 16, v6
    s_waitcnt vmcnt(19) lgkmcnt(2)
    v_mfma_f32_32x32x16_bf16 v[32:47], v[100:103], a[20:23], v[32:47]
    ds_read_b64_tr_b16 v[96:97], v130 offset:8192
    ds_read_b64_tr_b16 v[98:99], v130 offset:8704
    buffer_load_dwordx4 a[0:3], v1, s[4:7], s76 offen offset:3072 sc1
    s_waitcnt lgkmcnt(2)
    v_mfma_f32_32x32x16_bf16 v[48:63], v[108:111], a[20:23], v[48:63]
    ds_read_b64_tr_b16 v[104:105], v133 offset:8192
    ds_read_b64_tr_b16 v[106:107], v133 offset:8704
    v_and_b32 v117, s81, v6
    v_lshlrev_b32 v152, 16, v14
    v_and_b32 v153, s81, v14
    s_waitcnt vmcnt(19) lgkmcnt(2)
    v_mfma_f32_32x32x16_bf16 v[32:47], v[96:99], a[24:27], v[32:47]
    ds_read_b64_tr_b16 v[100:101], v130 offset:12288
    ds_read_b64_tr_b16 v[102:103], v130 offset:12800
    s_add_u32 s76, s76, 0x1000
    buffer_load_dwordx4 a[4:7], v1, s[4:7], s76 offen offset:0 sc1
    s_waitcnt lgkmcnt(2)
    v_mfma_f32_32x32x16_bf16 v[48:63], v[104:107], a[24:27], v[48:63]
    ds_read_b64_tr_b16 v[108:109], v133 offset:12288
    ds_read_b64_tr_b16 v[110:111], v133 offset:12800
    v_lshlrev_b32 v118, 16, v7
    v_and_b32 v119, s81, v7
    v_lshlrev_b32 v154, 16, v15
    s_waitcnt vmcnt(19) lgkmcnt(2)
    v_mfma_f32_32x32x16_bf16 v[32:47], v[100:103], a[28:31], v[32:47]
    ds_read_b64_tr_b16 v[96:97], v130 offset:16384
    ds_read_b64_tr_b16 v[98:99], v130 offset:16896
    buffer_load_dwordx4 a[8:11], v1, s[4:7], s76 offen offset:1024 sc1
    s_waitcnt lgkmcnt(2)
    v_mfma_f32_32x32x16_bf16 v[48:63], v[108:111], a[28:31], v[48:63]
    ds_read_b64_tr_b16 v[104:105], v133 offset:16384
    ds_read_b64_tr_b16 v[106:107], v133 offset:16896
    v_and_b32 v155, s81, v15
    v_lshlrev_b32 v120, 16, v8
    v_and_b32 v121, s81, v8
    s_waitcnt vmcnt(19) lgkmcnt(2)
    v_mfma_f32_32x32x16_bf16 v[32:47], v[96:99], a[32:35], v[32:47]
    ds_read_b64_tr_b16 v[100:101], v130 offset:20480
    ds_read_b64_tr_b16 v[102:103], v130 offset:20992
    buffer_load_dwordx4 a[12:15], v1, s[4:7], s76 offen offset:2048 sc1
    s_waitcnt lgkmcnt(2)
    v_mfma_f32_32x32x16_bf16 v[48:63], v[104:107], a[32:35], v[48:63]
    ds_read_b64_tr_b16 v[108:109], v133 offset:20480
    ds_read_b64_tr_b16 v[110:111], v133 offset:20992
    v_lshlrev_b32 v156, 16, v16
    v_and_b32 v157, s81, v16
    v_lshlrev_b32 v122, 16, v9
    s_waitcnt vmcnt(19) lgkmcnt(2)
    v_mfma_f32_32x32x16_bf16 v[32:47], v[100:103], a[36:39], v[32:47]
    ds_read_b64_tr_b16 v[96:97], v130 offset:24576
    ds_read_b64_tr_b16 v[98:99], v130 offset:25088
    s_add_u32 s76, s79, 28672
    buffer_load_dwordx4 a[16:19], v1, s[4:7], s76 offen offset:0 sc1
    s_waitcnt lgkmcnt(2)
    v_mfma_f32_32x32x16_bf16 v[48:63], v[108:111], a[36:39], v[48:63]
    ds_read_b64_tr_b16 v[104:105], v133 offset:24576
    ds_read_b64_tr_b16 v[106:107], v133 offset:25088
    v_and_b32 v123, s81, v9
    v_lshlrev_b32 v158, 16, v17
    v_and_b32 v159, s81, v17
    s_waitcnt vmcnt(15)
    s_lshl_b32 s64, s2, 2
    s_add_u32 s64, s64, s54
    s_lshl_b32 s64, s64, 7
    s_add_u32 s64, s64, 266240
    v_mov_b32 v26, s57
    v_mov_b32 v27, s64
    s_mov_b64 exec, 1
    buffer_store_dword v26, v27, s[4:7], 0 offen sc1
    s_mov_b64 exec, -1
    s_waitcnt lgkmcnt(2)
    v_mfma_f32_32x32x16_bf16 v[32:47], v[96:99], a[40:43], v[32:47]
    ds_read_b64_tr_b16 v[100:101], v128 offset:0
    ds_read_b64_tr_b16 v[102:103], v128 offset:512
    buffer_load_dwordx4 a[20:23], v1, s[4:7], s76 offen offset:1024 sc1
    s_waitcnt lgkmcnt(2)
    v_mfma_f32_32x32x16_bf16 v[48:63], v[104:107], a[40:43], v[48:63]
    ds_read_b64_tr_b16 v[108:109], v131 offset:0
    ds_read_b64_tr_b16 v[110:111], v131 offset:512
    v_lshlrev_b32 v124, 16, v10
    v_and_b32 v125, s81, v10
    v_lshlrev_b32 v160, 16, v18
    s_waitcnt lgkmcnt(2)
    v_mfma_f32_32x32x16_bf16 v[32:47], v[100:103], a[44:47], v[32:47]
    ds_read_b64_tr_b16 v[96:97], v128 offset:4096
    ds_read_b64_tr_b16 v[98:99], v128 offset:4608
    buffer_load_dwordx4 a[24:27], v1, s[4:7], s76 offen offset:2048 sc1
    s_waitcnt lgkmcnt(2)
    v_mfma_f32_32x32x16_bf16 v[48:63], v[108:111], a[44:47], v[48:63]
    ds_read_b64_tr_b16 v[104:105], v131 offset:4096
    ds_read_b64_tr_b16 v[106:107], v131 offset:4608
    v_and_b32 v161, s81, v18
    v_lshlrev_b32 v126, 16, v11
    v_and_b32 v127, s81, v11
    s_waitcnt lgkmcnt(2)
    v_mfma_f32_32x32x16_bf16 v[32:47], v[96:99], a[48:51], v[32:47]
    ds_read_b64_tr_b16 v[100:101], v128 offset:8192
    ds_read_b64_tr_b16 v[102:103], v128 offset:8704
    buffer_load_dwordx4 a[28:31], v1, s[4:7], s76 offen offset:3072 sc1
    s_waitcnt lgkmcnt(2)
    v_mfma_f32_32x32x16_bf16 v[48:63], v[104:107], a[48:51], v[48:63]
    ds_read_b64_tr_b16 v[108:109], v131 offset:8192
    ds_read_b64_tr_b16 v[110:111], v131 offset:8704
    v_lshlrev_b32 v162, 16, v19
    v_and_b32 v163, s81, v19
    v_add_f32 v148, v148, v112
    s_waitcnt lgkmcnt(2)
    v_mfma_f32_32x32x16_bf16 v[32:47], v[100:103], a[52:55], v[32:47]
    ds_read_b64_tr_b16 v[96:97], v128 offset:12288
    ds_read_b64_tr_b16 v[98:99], v128 offset:12800
    s_add_u32 s76, s76, 0x1000
    buffer_load_dwordx4 a[32:35], v1, s[4:7], s76 offen offset:0 sc1
    s_waitcnt lgkmcnt(2)
    v_mfma_f32_32x32x16_bf16 v[48:63], v[108:111], a[52:55], v[48:63]
    ds_read_b64_tr_b16 v[104:105], v131 offset:12288
    ds_read_b64_tr_b16 v[106:107], v131 offset:12800
    v_sub_f32 v112, v112, v20
    v_mul_f32 v112, v112, v21
    v_add_f32 v149, v149, v113
    s_waitcnt vmcnt(19) lgkmcnt(2)
    v_mfma_f32_32x32x16_bf16 v[32:47], v[96:99], a[56:59], v[32:47]
    ds_read_b64_tr_b16 v[100:101], v128 offset:16384
    ds_read_b64_tr_b16 v[102:103], v128 offset:16896
    buffer_load_dwordx4 a[36:39], v1, s[4:7], s76 offen offset:1024 sc1
    s_waitcnt lgkmcnt(2)
    v_mfma_f32_32x32x16_bf16 v[48:63], v[104:107], a[56:59], v[48:63]
    ds_read_b64_tr_b16 v[108:109], v131 offset:16384
    ds_read_b64_tr_b16 v[110:111], v131 offset:16896
    v_sub_f32 v113, v113, v20
    v_mul_f32 v113, v113, v21
    v_add_f32 v150, v150, v114
    s_waitcnt vmcnt(19) lgkmcnt(2)
    v_mfma_f32_32x32x16_bf16 v[32:47], v[100:103], a[60:63], v[32:47]
    ds_read_b64_tr_b16 v[96:97], v128 offset:20480
    ds_read_b64_tr_b16 v[98:99], v128 offset:20992
    buffer_load_dwordx4 a[40:43], v1, s[4:7], s76 offen offset:2048 sc1
    s_waitcnt lgkmcnt(2)
    v_mfma_f32_32x32x16_bf16 v[48:63], v[108:111], a[60:63], v[48:63]
    ds_read_b64_tr_b16 v[104:105], v131 offset:20480
    ds_read_b64_tr_b16 v[106:107], v131 offset:20992
    v_sub_f32 v114, v114, v20
    v_mul_f32 v114, v114, v21
    v_add_f32 v151, v151, v115
    s_waitcnt vmcnt(19) lgkmcnt(2)
    v_mfma_f32_32x32x16_bf16 v[32:47], v[96:99], v[64:67], v[32:47]
    ds_read_b64_tr_b16 v[100:101], v128 offset:24576
    ds_read_b64_tr_b16 v[102:103], v128 offset:25088
    s_add_u32 s76, s79, 35840
    buffer_load_dwordx4 a[44:47], v1, s[4:7], s76 offen offset:0 sc1
    s_waitcnt lgkmcnt(2)
    v_mfma_f32_32x32x16_bf16 v[48:63], v[104:107], v[64:67], v[48:63]
    ds_read_b64_tr_b16 v[108:109], v131 offset:24576
    ds_read_b64_tr_b16 v[110:111], v131 offset:25088
    v_sub_f32 v115, v115, v20
    v_mul_f32 v115, v115, v21
    v_add_f32 v152, v152, v116
    s_barrier
    s_waitcnt vmcnt(19) lgkmcnt(2)
    v_mfma_f32_32x32x16_bf16 v[32:47], v[100:103], v[68:71], v[32:47]
    ds_read_b64_tr_b16 v[96:97], v128 offset:28672
    ds_read_b64_tr_b16 v[98:99], v128 offset:29184
    buffer_load_dwordx4 a[48:51], v1, s[4:7], s76 offen offset:1024 sc1
    s_waitcnt lgkmcnt(2)
    v_mfma_f32_32x32x16_bf16 v[48:63], v[108:111], v[68:71], v[48:63]
    ds_read_b64_tr_b16 v[104:105], v131 offset:28672
    ds_read_b64_tr_b16 v[106:107], v131 offset:29184
    v_sub_f32 v116, v116, v20
    v_mul_f32 v116, v116, v21
    v_add_f32 v153, v153, v117
    s_waitcnt vmcnt(19) lgkmcnt(2)
    v_mfma_f32_32x32x16_bf16 v[32:47], v[96:99], v[72:75], v[32:47]
    ds_read_b64_tr_b16 v[100:101], v128 offset:32768
    ds_read_b64_tr_b16 v[102:103], v128 offset:33280
    buffer_load_dwordx4 a[52:55], v1, s[4:7], s76 offen offset:2048 sc1
    s_waitcnt lgkmcnt(2)
    v_mfma_f32_32x32x16_bf16 v[48:63], v[104:107], v[72:75], v[48:63]
    ds_read_b64_tr_b16 v[108:109], v131 offset:32768
    ds_read_b64_tr_b16 v[110:111], v131 offset:33280
    v_sub_f32 v117, v117, v20
    v_mul_f32 v117, v117, v21
    v_add_f32 v154, v154, v118
    s_waitcnt vmcnt(19) lgkmcnt(2)
    v_mfma_f32_32x32x16_bf16 v[32:47], v[100:103], v[76:79], v[32:47]
    ds_read_b64_tr_b16 v[96:97], v128 offset:36864
    ds_read_b64_tr_b16 v[98:99], v128 offset:37376
    buffer_load_dwordx4 a[56:59], v1, s[4:7], s76 offen offset:3072 sc1
    s_waitcnt lgkmcnt(2)
    v_mfma_f32_32x32x16_bf16 v[48:63], v[108:111], v[76:79], v[48:63]
    ds_read_b64_tr_b16 v[104:105], v131 offset:36864
    ds_read_b64_tr_b16 v[106:107], v131 offset:37376
    v_sub_f32 v118, v118, v20
    v_mul_f32 v118, v118, v21
    v_add_f32 v155, v155, v119
    s_waitcnt vmcnt(19) lgkmcnt(2)
    v_mfma_f32_32x32x16_bf16 v[32:47], v[96:99], v[80:83], v[32:47]
    ds_read_b64_tr_b16 v[100:101], v128 offset:40960
    ds_read_b64_tr_b16 v[102:103], v128 offset:41472
    s_add_u32 s76, s76, 0x1000
    buffer_load_dwordx4 a[60:63], v1, s[4:7], s76 offen offset:0 sc1
    s_waitcnt lgkmcnt(2)
    v_mfma_f32_32x32x16_bf16 v[48:63], v[104:107], v[80:83], v[48:63]
    ds_read_b64_tr_b16 v[108:109], v131 offset:40960
    ds_read_b64_tr_b16 v[110:111], v131 offset:41472
    v_sub_f32 v119, v119, v20
    v_mul_f32 v119, v119, v21
    v_add_f32 v156, v156, v120
    s_waitcnt vmcnt(19) lgkmcnt(2)
    v_mfma_f32_32x32x16_bf16 v[32:47], v[100:103], v[84:87], v[32:47]
    ds_read_b64_tr_b16 v[96:97], v128 offset:45056
    ds_read_b64_tr_b16 v[98:99], v128 offset:45568
    buffer_load_dwordx4 v[64:67], v1, s[4:7], s76 offen offset:1024 sc1
    s_waitcnt lgkmcnt(2)
    v_mfma_f32_32x32x16_bf16 v[48:63], v[108:111], v[84:87], v[48:63]
    ds_read_b64_tr_b16 v[104:105], v131 offset:45056
    ds_read_b64_tr_b16 v[106:107], v131 offset:45568
    v_sub_f32 v120, v120, v20
    v_mul_f32 v120, v120, v21
    v_add_f32 v157, v157, v121
    s_waitcnt vmcnt(19) lgkmcnt(2)
    v_mfma_f32_32x32x16_bf16 v[32:47], v[96:99], v[88:91], v[32:47]
    ds_read_b64_tr_b16 v[100:101], v128 offset:49152
    ds_read_b64_tr_b16 v[102:103], v128 offset:49664
    buffer_load_dwordx4 v[68:71], v1, s[4:7], s76 offen offset:2048 sc1
    s_waitcnt lgkmcnt(2)
    v_mfma_f32_32x32x16_bf16 v[48:63], v[104:107], v[88:91], v[48:63]
    ds_read_b64_tr_b16 v[108:109], v131 offset:49152
    ds_read_b64_tr_b16 v[110:111], v131 offset:49664
    v_sub_f32 v121, v121, v20
    v_mul_f32 v121, v121, v21
    v_add_f32 v158, v158, v122
    s_lshl_b32 s64, s53, 6
    s_lshl_b32 s78, s56, 5
    s_add_u32 s64, s64, s78
    s_lshr_b32 s64, s64, 1
    v_and_b32 v28, 15, v0
    v_add_u32 v28, s64, v28
    s_lshr_b32 s64, s60, 5
    s_lshl_b32 s64, s64, 1
    s_bfe_u32 s65, s60, 0x10003
    s_add_u32 s64, s64, s65
    v_lshl_add_u32 v28, v28, 2, s64
    v_lshlrev_b32 v171, 7, v28
    v_add_u32 v171, 266240, v171
    buffer_load_dword v170, v171, s[4:7], 0 offen sc1
    s_waitcnt vmcnt(20) lgkmcnt(2)
    v_mfma_f32_32x32x16_bf16 v[32:47], v[100:103], v[92:95], v[32:47]
    ds_read_b64_tr_b16 v[96:97], v128 offset:53248
    ds_read_b64_tr_b16 v[98:99], v128 offset:53760
    s_add_u32 s76, s79, 43008
    buffer_load_dwordx4 v[72:75], v1, s[4:7], s76 offen offset:0 sc1
    s_waitcnt lgkmcnt(2)
    v_mfma_f32_32x32x16_bf16 v[48:63], v[108:111], v[92:95], v[48:63]
    ds_read_b64_tr_b16 v[104:105], v131 offset:53248
    ds_read_b64_tr_b16 v[106:107], v131 offset:53760
    v_sub_f32 v122, v122, v20
    v_mul_f32 v122, v122, v21
    v_add_f32 v159, v159, v123
    s_waitcnt vmcnt(20) lgkmcnt(2)
    v_mfma_f32_32x32x16_bf16 v[32:47], v[96:99], a[0:3], v[32:47]
    ds_read_b64_tr_b16 v[100:101], v128 offset:57344
    ds_read_b64_tr_b16 v[102:103], v128 offset:57856
    buffer_load_dwordx4 v[76:79], v1, s[4:7], s76 offen offset:1024 sc1
    s_waitcnt lgkmcnt(2)
    v_mfma_f32_32x32x16_bf16 v[48:63], v[104:107], a[0:3], v[48:63]
    ds_read_b64_tr_b16 v[108:109], v131 offset:57344
    ds_read_b64_tr_b16 v[110:111], v131 offset:57856
    v_sub_f32 v123, v123, v20
    v_mul_f32 v123, v123, v21
    v_add_f32 v160, v160, v124
    s_waitcnt vmcnt(20) lgkmcnt(2)
    v_mfma_f32_32x32x16_bf16 v[32:47], v[100:103], a[4:7], v[32:47]
    ds_read_b64_tr_b16 v[96:97], v128 offset:61440
    ds_read_b64_tr_b16 v[98:99], v128 offset:61952
    buffer_load_dwordx4 v[80:83], v1, s[4:7], s76 offen offset:2048 sc1
    s_waitcnt lgkmcnt(2)
    v_mfma_f32_32x32x16_bf16 v[48:63], v[108:111], a[4:7], v[48:63]
    ds_read_b64_tr_b16 v[104:105], v131 offset:61440
    ds_read_b64_tr_b16 v[106:107], v131 offset:61952
    v_sub_f32 v124, v124, v20
    v_mul_f32 v124, v124, v21
    v_add_f32 v161, v161, v125
    s_waitcnt vmcnt(20) lgkmcnt(2)
    v_mfma_f32_32x32x16_bf16 v[32:47], v[96:99], a[8:11], v[32:47]
    ds_read_b64_tr_b16 v[100:101], v129 offset:0
    ds_read_b64_tr_b16 v[102:103], v129 offset:512
    buffer_load_dwordx4 v[84:87], v1, s[4:7], s76 offen offset:3072 sc1
    s_waitcnt lgkmcnt(2)
    v_mfma_f32_32x32x16_bf16 v[48:63], v[104:107], a[8:11], v[48:63]
    ds_read_b64_tr_b16 v[108:109], v132 offset:0
    ds_read_b64_tr_b16 v[110:111], v132 offset:512
    v_sub_f32 v125, v125, v20
    v_mul_f32 v125, v125, v21
    v_add_f32 v162, v162, v126
    s_waitcnt vmcnt(20) lgkmcnt(2)
    v_mfma_f32_32x32x16_bf16 v[32:47], v[100:103], a[12:15], v[32:47]
    ds_read_b64_tr_b16 v[96:97], v129 offset:4096
    ds_read_b64_tr_b16 v[98:99], v129 offset:4608
    s_add_u32 s76, s76, 0x1000
    buffer_load_dwordx4 v[88:91], v1, s[4:7], s76 offen offset:0 sc1
    s_waitcnt lgkmcnt(2)
    v_mfma_f32_32x32x16_bf16 v[48:63], v[108:111], a[12:15], v[48:63]
    ds_read_b64_tr_b16 v[104:105], v132 offset:4096
    ds_read_b64_tr_b16 v[106:107], v132 offset:4608
    v_sub_f32 v126, v126, v20
    v_mul_f32 v126, v126, v21
    v_add_f32 v163, v163, v127
    s_waitcnt vmcnt(20) lgkmcnt(2)
    v_mfma_f32_32x32x16_bf16 v[32:47], v[96:99], a[16:19], v[32:47]
    ds_read_b64_tr_b16 v[100:101], v129 offset:8192
    ds_read_b64_tr_b16 v[102:103], v129 offset:8704
    buffer_load_dwordx4 v[92:95], v1, s[4:7], s76 offen offset:1024 sc1
    s_waitcnt lgkmcnt(2)
    v_mfma_f32_32x32x16_bf16 v[48:63], v[104:107], a[16:19], v[48:63]
    ds_read_b64_tr_b16 v[108:109], v132 offset:8192
    ds_read_b64_tr_b16 v[110:111], v132 offset:8704
    v_sub_f32 v127, v127, v20
    v_mul_f32 v127, v127, v21
    s_waitcnt vmcnt(19) lgkmcnt(2)
    v_mfma_f32_32x32x16_bf16 v[32:47], v[100:103], a[20:23], v[32:47]
    ds_read_b64_tr_b16 v[96:97], v129 offset:12288
    ds_read_b64_tr_b16 v[98:99], v129 offset:12800
    buffer_load_dwordx4 a[0:3], v1, s[4:7], s76 offen offset:2048 sc1
    s_waitcnt lgkmcnt(2)
    v_mfma_f32_32x32x16_bf16 v[48:63], v[108:111], a[20:23], v[48:63]
    ds_read_b64_tr_b16 v[104:105], v132 offset:12288
    ds_read_b64_tr_b16 v[106:107], v132 offset:12800
    s_waitcnt vmcnt(19) lgkmcnt(2)
    v_mfma_f32_32x32x16_bf16 v[32:47], v[96:99], a[24:27], v[32:47]
    ds_read_b64_tr_b16 v[100:101], v129 offset:16384
    ds_read_b64_tr_b16 v[102:103], v129 offset:16896
    s_add_u32 s76, s79, 50176
    buffer_load_dwordx4 a[4:7], v1, s[4:7], s76 offen offset:0 sc1
    s_waitcnt lgkmcnt(2)
    v_mfma_f32_32x32x16_bf16 v[48:63], v[104:107], a[24:27], v[48:63]
    ds_read_b64_tr_b16 v[108:109], v132 offset:16384
    ds_read_b64_tr_b16 v[110:111], v132 offset:16896
    s_barrier
    s_waitcnt vmcnt(19) lgkmcnt(2)
    v_mfma_f32_32x32x16_bf16 v[32:47], v[100:103], a[28:31], v[32:47]
    ds_read_b64_tr_b16 v[96:97], v129 offset:20480
    ds_read_b64_tr_b16 v[98:99], v129 offset:20992
    buffer_load_dwordx4 a[8:11], v1, s[4:7], s76 offen offset:1024 sc1
    s_waitcnt lgkmcnt(2)
    v_mfma_f32_32x32x16_bf16 v[48:63], v[108:111], a[28:31], v[48:63]
    ds_read_b64_tr_b16 v[104:105], v132 offset:20480
    ds_read_b64_tr_b16 v[106:107], v132 offset:20992
    s_waitcnt vmcnt(19) lgkmcnt(2)
    v_mfma_f32_32x32x16_bf16 v[32:47], v[96:99], a[32:35], v[32:47]
    ds_read_b64_tr_b16 v[100:101], v129 offset:24576
    ds_read_b64_tr_b16 v[102:103], v129 offset:25088
    buffer_load_dwordx4 a[12:15], v1, s[4:7], s76 offen offset:2048 sc1
    s_waitcnt lgkmcnt(2)
    v_mfma_f32_32x32x16_bf16 v[48:63], v[104:107], a[32:35], v[48:63]
    ds_read_b64_tr_b16 v[108:109], v132 offset:24576
    ds_read_b64_tr_b16 v[110:111], v132 offset:25088
    s_waitcnt vmcnt(19) lgkmcnt(2)
    v_mfma_f32_32x32x16_bf16 v[32:47], v[100:103], a[36:39], v[32:47]
    ds_read_b64_tr_b16 v[96:97], v129 offset:28672
    ds_read_b64_tr_b16 v[98:99], v129 offset:29184
    buffer_load_dwordx4 a[16:19], v1, s[4:7], s76 offen offset:3072 sc1
    s_waitcnt lgkmcnt(2)
    v_mfma_f32_32x32x16_bf16 v[48:63], v[108:111], a[36:39], v[48:63]
    ds_read_b64_tr_b16 v[104:105], v132 offset:28672
    ds_read_b64_tr_b16 v[106:107], v132 offset:29184
    s_waitcnt vmcnt(19) lgkmcnt(2)
    v_mfma_f32_32x32x16_bf16 v[32:47], v[96:99], a[40:43], v[32:47]
    ds_read_b64_tr_b16 v[100:101], v129 offset:32768
    ds_read_b64_tr_b16 v[102:103], v129 offset:33280
    s_add_u32 s76, s76, 0x1000
    buffer_load_dwordx4 a[20:23], v1, s[4:7], s76 offen offset:0 sc1
    s_waitcnt lgkmcnt(2)
    v_mfma_f32_32x32x16_bf16 v[48:63], v[104:107], a[40:43], v[48:63]
    ds_read_b64_tr_b16 v[108:109], v132 offset:32768
    ds_read_b64_tr_b16 v[110:111], v132 offset:33280
    s_waitcnt vmcnt(12)
    v_cmp_ne_u32 vcc, s57, v170
    s_nop 0
    s_cmp_eq_u64 vcc, 0
    s_cbranch_scc1 L_polled_19
    s_mov_b32 s86, 0x40000
L_poll_18:
    buffer_load_dword v170, v171, s[4:7], 0 offen sc1
    s_waitcnt vmcnt(0)
    v_cmp_ne_u32 vcc, s57, v170
    s_nop 0
    s_cmp_eq_u64 vcc, 0
    s_cbranch_scc1 L_polled_19
    s_sub_u32 s86, s86, 1
    s_cmp_lg_u32 s86, 0
    s_cbranch_scc1 L_poll_18
    v_mov_b32 v26, 0
    v_mov_b32 v27, 260
    s_mov_b64 exec, 1
    global_store_dword v26, v27, s[30:31]
    s_mov_b64 exec, -1
L_polled_19:
    s_lshl_b32 s68, s53, 18
    s_lshl_b32 s78, s56, 17
    s_add_u32 s68, s68, s78
    s_lshl_b32 s65, s60, 6
    s_add_u32 s68, s68, s65
    s_add_u32 s68, s68, 0x300000
    s_add_u32 s65, s68, 0x10000
    v_lshrrev_b32 v147, 2, v0
    v_lshlrev_b32 v147, 12, v147
    v_and_b32 v26, 3, v0
    v_lshl_add_u32 v147, v26, 4, v147
    buffer_load_dwordx4 v[172:175], v147, s[4:7], s68 offen sc1
    buffer_load_dwordx4 v[176:179], v147, s[4:7], s65 offen sc1
    s_waitcnt lgkmcnt(2)
    v_mfma_f32_32x32x16_bf16 v[32:47], v[100:103], a[44:47], v[32:47]
    ds_read_b64_tr_b16 v[96:97], v129 offset:36864
    ds_read_b64_tr_b16 v[98:99], v129 offset:37376
    buffer_load_dwordx4 a[24:27], v1, s[4:7], s76 offen offset:1024 sc1
    s_waitcnt lgkmcnt(2)
    v_mfma_f32_32x32x16_bf16 v[48:63], v[108:111], a[44:47], v[48:63]
    ds_read_b64_tr_b16 v[104:105], v132 offset:36864
    ds_read_b64_tr_b16 v[106:107], v132 offset:37376
    s_waitcnt lgkmcnt(2)
    v_mfma_f32_32x32x16_bf16 v[32:47], v[96:99], a[48:51], v[32:47]
    ds_read_b64_tr_b16 v[100:101], v129 offset:40960
    ds_read_b64_tr_b16 v[102:103], v129 offset:41472
    buffer_load_dwordx4 a[28:31], v1, s[4:7], s76 offen offset:2048 sc1
    s_waitcnt lgkmcnt(2)
    v_mfma_f32_32x32x16_bf16 v[48:63], v[104:107], a[48:51], v[48:63]
    ds_read_b64_tr_b16 v[108:109], v132 offset:40960
    ds_read_b64_tr_b16 v[110:111], v132 offset:41472
    s_waitcnt lgkmcnt(2)
    v_mfma_f32_32x32x16_bf16 v[32:47], v[100:103], a[52:55], v[32:47]
    ds_read_b64_tr_b16 v[96:97], v129 offset:45056
    ds_read_b64_tr_b16 v[98:99], v129 offset:45568
    s_waitcnt lgkmcnt(2)
    v_mfma_f32_32x32x16_bf16 v[48:63], v[108:111], a[52:55], v[48:63]
    ds_read_b64_tr_b16 v[104:105], v132 offset:45056
    ds_read_b64_tr_b16 v[106:107], v132 offset:45568
    s_waitcnt lgkmcnt(2)
    v_mfma_f32_32x32x16_bf16 v[32:47], v[96:99], a[56:59], v[32:47]
    ds_read_b64_tr_b16 v[100:101], v129 offset:49152
    ds_read_b64_tr_b16 v[102:103], v129 offset:49664
    s_waitcnt lgkmcnt(2)
    v_mfma_f32_32x32x16_bf16 v[48:63], v[104:107], a[56:59], v[48:63]
    ds_read_b64_tr_b16 v[108:109], v132 offset:49152
    ds_read_b64_tr_b16 v[110:111], v132 offset:49664
    s_waitcnt lgkmcnt(2)
    v_mfma_f32_32x32x16_bf16 v[32:47], v[100:103], a[60:63], v[32:47]
    ds_read_b64_tr_b16 v[96:97], v129 offset:53248
    ds_read_b64_tr_b16 v[98:99], v129 offset:53760
    s_waitcnt lgkmcnt(2)
    v_mfma_f32_32x32x16_bf16 v[48:63], v[108:111], a[60:63], v[48:63]
    ds_read_b64_tr_b16 v[104:105], v132 offset:53248
    ds_read_b64_tr_b16 v[106:107], v132 offset:53760
    s_waitcnt lgkmcnt(2)
    v_mfma_f32_32x32x16_bf16 v[32:47], v[96:99], v[64:67], v[32:47]
    ds_read_b64_tr_b16 v[100:101], v129 offset:57344
    ds_read_b64_tr_b16 v[102:103], v129 offset:57856
    s_waitcnt lgkmcnt(2)
    v_mfma_f32_32x32x16_bf16 v[48:63], v[104:107], v[64:67], v[48:63]
    ds_read_b64_tr_b16 v[108:109], v132 offset:57344
    ds_read_b64_tr_b16 v[110:111], v132 offset:57856
    s_waitcnt lgkmcnt(2)
    v_mfma_f32_32x32x16_bf16 v[32:47], v[100:103], v[68:71], v[32:47]
    ds_read_b64_tr_b16 v[96:97], v129 offset:61440
    ds_read_b64_tr_b16 v[98:99], v129 offset:61952
    s_waitcnt lgkmcnt(2)
    v_mfma_f32_32x32x16_bf16 v[48:63], v[108:111], v[68:71], v[48:63]
    ds_read_b64_tr_b16 v[104:105], v132 offset:61440
    ds_read_b64_tr_b16 v[106:107], v132 offset:61952
    s_waitcnt vmcnt(15) lgkmcnt(2)
    v_mfma_f32_32x32x16_bf16 v[32:47], v[96:99], v[72:75], v[32:47]
    ds_read_b64_tr_b16 v[100:101], v130 offset:0
    ds_read_b64_tr_b16 v[102:103], v130 offset:512
    s_waitcnt lgkmcnt(2)
    v_mfma_f32_32x32x16_bf16 v[48:63], v[104:107], v[72:75], v[48:63]
    ds_read_b64_tr_b16 v[108:109], v133 offset:0
    ds_read_b64_tr_b16 v[110:111], v133 offset:512
    s_waitcnt vmcnt(14) lgkmcnt(2)
    v_mfma_f32_32x32x16_bf16 v[32:47], v[100:103], v[76:79], v[32:47]
    ds_read_b64_tr_b16 v[96:97], v130 offset:4096
    ds_read_b64_tr_b16 v[98:99], v130 offset:4608
    s_waitcnt lgkmcnt(2)
    v_mfma_f32_32x32x16_bf16 v[48:63], v[108:111], v[76:79], v[48:63]
    ds_read_b64_tr_b16 v[104:105], v133 offset:4096
    ds_read_b64_tr_b16 v[106:107], v133 offset:4608
    s_waitcnt vmcnt(13) lgkmcnt(2)
    v_mfma_f32_32x32x16_bf16 v[32:47], v[96:99], v[80:83], v[32:47]
    ds_read_b64_tr_b16 v[100:101], v130 offset:8192
    ds_read_b64_tr_b16 v[102:103], v130 offset:8704
    s_waitcnt lgkmcnt(2)
    v_mfma_f32_32x32x16_bf16 v[48:63], v[104:107], v[80:83], v[48:63]
    ds_read_b64_tr_b16 v[108:109], v133 offset:8192
    ds_read_b64_tr_b16 v[110:111], v133 offset:8704
    s_waitcnt vmcnt(12) lgkmcnt(2)
    v_mfma_f32_32x32x16_bf16 v[32:47], v[100:103], v[84:87], v[32:47]
    ds_read_b64_tr_b16 v[96:97], v130 offset:12288
    ds_read_b64_tr_b16 v[98:99], v130 offset:12800
    s_waitcnt lgkmcnt(2)
    v_mfma_f32_32x32x16_bf16 v[48:63], v[108:111], v[84:87], v[48:63]
    ds_read_b64_tr_b16 v[104:105], v133 offset:12288
    ds_read_b64_tr_b16 v[106:107], v133 offset:12800
    s_waitcnt vmcnt(11) lgkmcnt(2)
    v_mfma_f32_32x32x16_bf16 v[32:47], v[96:99], v[88:91], v[32:47]
    ds_read_b64_tr_b16 v[100:101], v130 offset:16384
    ds_read_b64_tr_b16 v[102:103], v130 offset:16896
    s_waitcnt lgkmcnt(2)
    v_mfma_f32_32x32x16_bf16 v[48:63], v[104:107], v[88:91], v[48:63]
    ds_read_b64_tr_b16 v[108:109], v133 offset:16384
    ds_read_b64_tr_b16 v[110:111], v133 offset:16896
    s_waitcnt vmcnt(2)
    s_lshl_b32 s65, s54, 11
    s_add_u32 s65, s65, 49152
    v_add_u32 v147, s65, v1
    ds_write_b128 v147, v[172:175]
    ds_write_b128 v147, v[176:179] offset:1024
    v_add_u32 v147, s65, v2
    s_waitcnt lgkmcnt(4)
    v_mfma_f32_32x32x16_bf16 v[32:47], v[100:103], v[92:95], v[32:47]
    ds_read_b64_tr_b16 v[96:97], v130 offset:20480
    ds_read_b64_tr_b16 v[98:99], v130 offset:20992
    s_waitcnt lgkmcnt(4)
    v_mfma_f32_32x32x16_bf16 v[48:63], v[108:111], v[92:95], v[48:63]
    ds_read_b64_tr_b16 v[104:105], v133 offset:20480
    ds_read_b64_tr_b16 v[106:107], v133 offset:20992
    s_waitcnt lgkmcnt(2)
    v_mfma_f32_32x32x16_bf16 v[32:47], v[96:99], a[0:3], v[32:47]
    ds_read_b64_tr_b16 v[100:101], v130 offset:24576
    ds_read_b64_tr_b16 v[102:103], v130 offset:25088
    s_waitcnt lgkmcnt(2)
    v_mfma_f32_32x32x16_bf16 v[48:63], v[104:107], a[0:3], v[48:63]
    ds_read_b64_tr_b16 v[108:109], v133 offset:24576
    ds_read_b64_tr_b16 v[110:111], v133 offset:25088
    ds_read_b64_tr_b16 v[180:181], v147 offset:0
    ds_read_b64_tr_b16 v[182:183], v147 offset:512
    ds_read_b64_tr_b16 v[184:185], v147 offset:1024
    ds_read_b64_tr_b16 v[186:187], v147 offset:1536
    s_waitcnt lgkmcnt(6)
    v_mfma_f32_32x32x16_bf16 v[32:47], v[100:103], a[4:7], v[32:47]
    ds_read_b64_tr_b16 v[96:97], v128 offset:0
    ds_read_b64_tr_b16 v[98:99], v128 offset:512
    s_waitcnt lgkmcnt(6)
    v_mfma_f32_32x32x16_bf16 v[48:63], v[108:111], a[4:7], v[48:63]
    ds_read_b64_tr_b16 v[104:105], v131 offset:0
    ds_read_b64_tr_b16 v[106:107], v131 offset:512
    s_waitcnt lgkmcnt(2)
    v_mfma_f32_32x32x16_bf16 v[32:47], v[96:99], a[8:11], v[32:47]
    ds_read_b64_tr_b16 v[100:101], v128 offset:4096
    ds_read_b64_tr_b16 v[102:103], v128 offset:4608
    s_waitcnt lgkmcnt(2)
    v_mfma_f32_32x32x16_bf16 v[48:63], v[104:107], a[8:11], v[48:63]
    ds_read_b64_tr_b16 v[108:109], v131 offset:4096
    ds_read_b64_tr_b16 v[110:111], v131 offset:4608
    v_lshlrev_b32 v164, 16, v180
    v_and_b32 v165, s81, v180
    v_fmac_f32 v148, v112, v164
    v_fmac_f32 v149, v113, v165
    v_lshlrev_b32 v164, 16, v181
    s_waitcnt lgkmcnt(2)
    v_mfma_f32_32x32x16_bf16 v[32:47], v[100:103], a[12:15], v[32:47]
    ds_read_b64_tr_b16 v[96:97], v128 offset:8192
    ds_read_b64_tr_b16 v[98:99], v128 offset:8704
    s_waitcnt lgkmcnt(2)
    v_mfma_f32_32x32x16_bf16 v[48:63], v[108:111], a[12:15], v[48:63]
    ds_read_b64_tr_b16 v[104:105], v131 offset:8192
    ds_read_b64_tr_b16 v[106:107], v131 offset:8704
    v_and_b32 v165, s81, v181
    v_fmac_f32 v150, v114, v164
    v_fmac_f32 v151, v115, v165
    v_lshlrev_b32 v164, 16, v182
    v_and_b32 v165, s81, v182
    s_waitcnt lgkmcnt(2)
    v_mfma_f32_32x32x16_bf16 v[32:47], v[96:99], a[16:19], v[32:47]
    ds_read_b64_tr_b16 v[100:101], v128 offset:12288
    ds_read_b64_tr_b16 v[102:103], v128 offset:12800
    s_waitcnt lgkmcnt(2)
    v_mfma_f32_32x32x16_bf16 v[48:63], v[104:107], a[16:19], v[48:63]
    ds_read_b64_tr_b16 v[108:109], v131 offset:12288
    ds_read_b64_tr_b16 v[110:111], v131 offset:12800
    v_fmac_f32 v152, v116, v164
    v_fmac_f32 v153, v117, v165
    v_lshlrev_b32 v164, 16, v183
    v_and_b32 v165, s81, v183
    v_fmac_f32 v154, v118, v164
    s_waitcnt lgkmcnt(2)
    v_mfma_f32_32x32x16_bf16 v[32:47], v[100:103], a[20:23], v[32:47]
    ds_read_b64_tr_b16 v[96:97], v128 offset:16384
    ds_read_b64_tr_b16 v[98:99], v128 offset:16896
    s_waitcnt lgkmcnt(2)
    v_mfma_f32_32x32x16_bf16 v[48:63], v[108:111], a[20:23], v[48:63]
    ds_read_b64_tr_b16 v[104:105], v131 offset:16384
    ds_read_b64_tr_b16 v[106:107], v131 offset:16896
    v_fmac_f32 v155, v119, v165
    v_lshlrev_b32 v164, 16, v184
    v_and_b32 v165, s81, v184
    v_fmac_f32 v156, v120, v164
    v_fmac_f32 v157, v121, v165
    s_waitcnt vmcnt(1) lgkmcnt(2)
    v_mfma_f32_32x32x16_bf16 v[32:47], v[96:99], a[24:27], v[32:47]
    ds_read_b64_tr_b16 v[100:101], v128 offset:20480
    ds_read_b64_tr_b16 v[102:103], v128 offset:20992
    s_waitcnt lgkmcnt(2)
    v_mfma_f32_32x32x16_bf16 v[48:63], v[104:107], a[24:27], v[48:63]
    ds_read_b64_tr_b16 v[108:109], v131 offset:20480
    ds_read_b64_tr_b16 v[110:111], v131 offset:20992
    v_lshlrev_b32 v164, 16, v185
    v_and_b32 v165, s81, v185
    v_fmac_f32 v158, v122, v164
    v_fmac_f32 v159, v123, v165
    v_lshlrev_b32 v164, 16, v186
    s_waitcnt vmcnt(0) lgkmcnt(2)
    v_mfma_f32_32x32x16_bf16 v[32:47], v[100:103], a[28:31], v[32:47]
    s_waitcnt lgkmcnt(0)
    v_mfma_f32_32x32x16_bf16 v[48:63], v[108:111], a[28:31], v[48:63]
    v_and_b32 v165, s81, v186
    v_fmac_f32 v160, v124, v164
    v_fmac_f32 v161, v125, v165
    v_lshlrev_b32 v164, 16, v187
    v_and_b32 v165, s81, v187
    s_lshl_b32 s68, s60, 15
    s_lshl_b32 s65, s53, 7
    s_lshl_b32 s78, s56, 6
    s_add_u32 s65, s65, s78
    s_add_u32 s68, s68, s65
    v_lshlrev_b32 v146, 10, v24
    v_lshl_add_u32 v146, v23, 4, v146
    v_add_u32 v146, s68, v146
    s_lshl_b32 s64, s54, 12
    s_add_u32 s64, s64, 24576
    v_add_u32 v26, s64, v1
    ds_write_b128 v26, v[48:51] offset:0
    ds_write_b128 v26, v[52:55] offset:1024
    ds_write_b128 v26, v[56:59] offset:2048
    ds_write_b128 v26, v[60:63] offset:3072
    v_fmac_f32 v162, v126, v164
    v_fmac_f32 v163, v127, v165
    v_pk_add_f32 v[32:33], v[32:33], v[148:149]
    v_pk_add_f32 v[34:35], v[34:35], v[150:151]
    v_pk_add_f32 v[36:37], v[36:37], v[152:153]
    v_pk_add_f32 v[38:39], v[38:39], v[154:155]
    v_pk_add_f32 v[40:41], v[40:41], v[156:157]
    v_pk_add_f32 v[42:43], v[42:43], v[158:159]
    v_pk_add_f32 v[44:45], v[44:45], v[160:161]
    v_pk_add_f32 v[46:47], v[46:47], v[162:163]
    s_waitcnt lgkmcnt(0)
    s_barrier
    s_xor_b32 s64, s54, 1
    s_lshl_b32 s64, s64, 12
    s_add_u32 s64, s64, 24576
    v_add_u32 v26, s64, v1
    ds_read_b128 v[80:83], v26 offset:0
    ds_read_b128 v[84:87], v26 offset:1024
    ds_read_b128 v[88:91], v26 offset:2048
    ds_read_b128 v[92:95], v26 offset:3072
    s_waitcnt lgkmcnt(0)
    v_pk_add_f32 v[32:33], v[32:33], v[80:81]
    v_pk_add_f32 v[34:35], v[34:35], v[82:83]
    v_pk_add_f32 v[36:37], v[36:37], v[84:85]
    v_pk_add_f32 v[38:39], v[38:39], v[86:87]
    v_pk_add_f32 v[40:41], v[40:41], v[88:89]
    v_pk_add_f32 v[42:43], v[42:43], v[90:91]
    v_pk_add_f32 v[44:45], v[44:45], v[92:93]
    v_pk_add_f32 v[46:47], v[46:47], v[94:95]
    v_cvt_pk_bf16_f32 v48, v32, v33
    v_cvt_pk_bf16_f32 v49, v34, v35
    v_cvt_pk_bf16_f32 v50, v36, v37
    v_cvt_pk_bf16_f32 v51, v38, v39
    v_cvt_pk_bf16_f32 v52, v40, v41
    v_cvt_pk_bf16_f32 v53, v42, v43
    v_cvt_pk_bf16_f32 v54, v44, v45
    v_cvt_pk_bf16_f32 v55, v46, v47
    v_permlane32_swap_b32 v48, v50
    v_permlane32_swap_b32 v49, v51
    v_permlane32_swap_b32 v52, v54
    v_permlane32_swap_b32 v53, v55
    buffer_store_dwordx4 v[48:51], v146, s[48:51], 0 offen
    buffer_store_dwordx4 v[52:55], v146, s[48:51], 0 offen offset:32
    s_waitcnt vmcnt(0)
L_end:
    s_endpgm
L_loader:
    v_lshrrev_b32 v26, 2, v0
    v_and_b32 v27, 3, v0
    v_lshlrev_b32 v27, 4, v27
    v_lshl_add_u32 v31, v26, 10, v27
    v_lshrrev_b32 v26, 3, v0
    v_and_b32 v27, 7, v0
    v_lshrrev_b32 v28, 4, v0
    v_xor_b32 v27, v27, v28
    v_lshlrev_b32 v27, 4, v27
    v_lshl_add_u32 v155, v26, 10, v27
    v_xor_b32 v156, 64, v155
    s_lshl_b32 s66, s54, 14
    s_lshl_b32 s67, s60, 15
    s_lshl_b32 s64, s56, 9
    s_add_u32 s67, s67, s64
    s_lshl_b32 s70, s55, 15
    s_lshl_b32 s64, s56, 14
    s_add_u32 s70, s70, s64
    s_add_u32 s70, s70, 65536
    s_lshl_b32 s71, s56, 18
    s_lshl_b32 s64, s53, 7
    s_lshl_b32 s78, s55, 6
    s_add_u32 s64, s64, s78
    s_add_u32 s71, s71, s64
    s_getpc_b64 s[96:97]
L_pc:
    s_sub_u32 s96, s96, L_pc-parallel_sum__ssm_conv_h3__mixer_s_mlp__prompt_kernel
    s_subb_u32 s97, s97, 0
    s_lshr_b32 s68, s2, 3
    s_lshl_b32 s68, s68, 2
    s_add_u32 s68, s68, s54
    s_mul_i32 s68, s68, 3
    v_min_u32 v26, 2, v0
    v_add_u32 v26, s68, v26
    v_min_u32 v26, (L_codeend-parallel_sum__ssm_conv_h3__mixer_s_mlp__prompt_kernel)/128-1, v26
    v_lshlrev_b32 v26, 7, v26
    v_mov_b32 v135, s97
    v_add_co_u32 v134, vcc, s96, v26
    s_nop 1
    v_addc_co_u32 v135, vcc, 0, v135, vcc
    global_load_dword v136, v[134:135], off
    s_add_u32 s65, s92, 0
    s_and_b32 s65, s65, 3
    s_lshl_b32 s93, s65, 7
    s_add_u32 s93, s93, s67
    s_lshl_b32 s94, s65, 16
    s_add_u32 s94, s94, s71
    s_add_u32 m0, s66, 0
    s_add_u32 s78, s93, 0
    buffer_load_dwordx4 v155, s[8:11], s78 offen lds
    s_add_u32 m0, s66, 1024
    s_add_u32 s78, s93, 8192
    buffer_load_dwordx4 v156, s[8:11], s78 offen lds
    s_add_u32 m0, s66, 2048
    s_add_u32 s78, s93, 16384
    buffer_load_dwordx4 v155, s[8:11], s78 offen lds
    s_add_u32 m0, s66, 3072
    s_add_u32 s78, s93, 24576
    buffer_load_dwordx4 v156, s[8:11], s78 offen lds
    s_add_u32 m0, s70, 0
    s_add_u32 s78, s94, 0
    buffer_load_dwordx4 v31, s[32:35], s78 offen lds
    s_add_u32 m0, s70, 1024
    s_add_u32 s78, s94, 16384
    buffer_load_dwordx4 v31, s[32:35], s78 offen lds
    s_add_u32 m0, s70, 2048
    s_add_u32 s78, s94, 32768
    buffer_load_dwordx4 v31, s[32:35], s78 offen lds
    s_add_u32 m0, s70, 3072
    s_add_u32 s78, s94, 49152
    buffer_load_dwordx4 v31, s[32:35], s78 offen lds
    s_add_u32 s65, s92, 1
    s_and_b32 s65, s65, 3
    s_lshl_b32 s93, s65, 7
    s_add_u32 s93, s93, s67
    s_lshl_b32 s94, s65, 16
    s_add_u32 s94, s94, s71
    s_add_u32 m0, s66, 4096
    s_add_u32 s78, s93, 0
    buffer_load_dwordx4 v155, s[8:11], s78 offen lds
    s_add_u32 m0, s66, 5120
    s_add_u32 s78, s93, 8192
    buffer_load_dwordx4 v156, s[8:11], s78 offen lds
    s_add_u32 m0, s66, 6144
    s_add_u32 s78, s93, 16384
    buffer_load_dwordx4 v155, s[8:11], s78 offen lds
    s_add_u32 m0, s66, 7168
    s_add_u32 s78, s93, 24576
    buffer_load_dwordx4 v156, s[8:11], s78 offen lds
    s_add_u32 m0, s70, 4096
    s_add_u32 s78, s94, 0
    buffer_load_dwordx4 v31, s[32:35], s78 offen lds
    s_add_u32 m0, s70, 5120
    s_add_u32 s78, s94, 16384
    buffer_load_dwordx4 v31, s[32:35], s78 offen lds
    s_add_u32 m0, s70, 6144
    s_add_u32 s78, s94, 32768
    buffer_load_dwordx4 v31, s[32:35], s78 offen lds
    s_add_u32 m0, s70, 7168
    s_add_u32 s78, s94, 49152
    buffer_load_dwordx4 v31, s[32:35], s78 offen lds
    s_waitcnt vmcnt(8)
    s_barrier
    s_add_u32 s65, s92, 2
    s_and_b32 s65, s65, 3
    s_lshl_b32 s93, s65, 7
    s_add_u32 s93, s93, s67
    s_lshl_b32 s94, s65, 16
    s_add_u32 s94, s94, s71
    s_add_u32 m0, s66, 8192
    s_add_u32 s78, s93, 0
    buffer_load_dwordx4 v155, s[8:11], s78 offen lds
    s_add_u32 m0, s66, 9216
    s_add_u32 s78, s93, 8192
    buffer_load_dwordx4 v156, s[8:11], s78 offen lds
    s_add_u32 m0, s66, 10240
    s_add_u32 s78, s93, 16384
    buffer_load_dwordx4 v155, s[8:11], s78 offen lds
    s_add_u32 m0, s66, 11264
    s_add_u32 s78, s93, 24576
    buffer_load_dwordx4 v156, s[8:11], s78 offen lds
    s_add_u32 m0, s70, 8192
    s_add_u32 s78, s94, 0
    buffer_load_dwordx4 v31, s[32:35], s78 offen lds
    s_add_u32 m0, s70, 9216
    s_add_u32 s78, s94, 16384
    buffer_load_dwordx4 v31, s[32:35], s78 offen lds
    s_add_u32 m0, s70, 10240
    s_add_u32 s78, s94, 32768
    buffer_load_dwordx4 v31, s[32:35], s78 offen lds
    s_add_u32 m0, s70, 11264
    s_add_u32 s78, s94, 49152
    buffer_load_dwordx4 v31, s[32:35], s78 offen lds
    s_waitcnt vmcnt(8)
    s_barrier
    s_add_u32 s65, s92, 3
    s_and_b32 s65, s65, 3
    s_lshl_b32 s93, s65, 7
    s_add_u32 s93, s93, s67
    s_lshl_b32 s94, s65, 16
    s_add_u32 s94, s94, s71
    s_add_u32 m0, s66, 12288
    s_add_u32 s78, s93, 0
    buffer_load_dwordx4 v155, s[8:11], s78 offen lds
    s_add_u32 m0, s66, 13312
    s_add_u32 s78, s93, 8192
    buffer_load_dwordx4 v156, s[8:11], s78 offen lds
    s_add_u32 m0, s66, 14336
    s_add_u32 s78, s93, 16384
    buffer_load_dwordx4 v155, s[8:11], s78 offen lds
    s_add_u32 m0, s66, 15360
    s_add_u32 s78, s93, 24576
    buffer_load_dwordx4 v156, s[8:11], s78 offen lds
    s_add_u32 m0, s70, 12288
    s_add_u32 s78, s94, 0
    buffer_load_dwordx4 v31, s[32:35], s78 offen lds
    s_add_u32 m0, s70, 13312
    s_add_u32 s78, s94, 16384
    buffer_load_dwordx4 v31, s[32:35], s78 offen lds
    s_add_u32 m0, s70, 14336
    s_add_u32 s78, s94, 32768
    buffer_load_dwordx4 v31, s[32:35], s78 offen lds
    s_add_u32 m0, s70, 15360
    s_add_u32 s78, s94, 49152
    buffer_load_dwordx4 v31, s[32:35], s78 offen lds
    s_lshl_b32 s64, s52, 6
    s_mul_i32 s65, s54, 17
    s_add_u32 s64, s64, s65
    s_add_i32 s64, s64, -3
    v_add_u32 v26, s64, v0
    v_lshlrev_b32 v26, 10, v26
    s_lshl_b32 s65, s53, 7
    v_add_u32 v26, s65, v26
    v_mov_b32 v27, 0x40000000
    v_cmp_gt_u32 vcc, 17, v0
    s_nop 1
    v_cndmask_b32 v26, v27, v26, vcc
    buffer_load_dword v157, v26, s[12:15], 0 offen
    s_lshl_b32 s64, s52, 6
    s_mul_i32 s65, s54, 16
    s_add_u32 s64, s64, s65
    s_add_i32 s64, s64, 0
    v_add_u32 v26, s64, v0
    v_lshlrev_b32 v26, 10, v26
    s_lshl_b32 s65, s53, 7
    v_add_u32 v26, s65, v26
    v_mov_b32 v27, 0x40000000
    v_cmp_gt_u32 vcc, 16, v0
    s_nop 1
    v_cndmask_b32 v26, v27, v26, vcc
    buffer_load_dword v158, v26, s[16:19], 0 offen
    s_lshr_b32 s68, s2, 3
    s_lshl_b32 s68, s68, 2
    s_add_u32 s68, s68, s54
    s_mul_i32 s64, s68, 32
    v_add_u32 v26, s64, v0
    v_lshlrev_b32 v26, 7, v26
    v_mov_b32 v27, 0x40000000
    v_cmp_gt_u32 vcc, 32, v0
    s_nop 1
    v_cndmask_b32 v26, v27, v26, vcc
    buffer_load_dword v159, v26, s[36:39], 0 offen
    s_lshl_b32 s68, s2, 3
    s_add_u32 s68, s68, s54
    s_mul_i32 s64, s68, 8
    v_add_u32 v26, s64, v0
    v_lshlrev_b32 v26, 7, v26
    v_mov_b32 v27, 0x40000000
    v_cmp_gt_u32 vcc, 8, v0
    s_nop 1
    v_cndmask_b32 v26, v27, v26, vcc
    buffer_load_dword v161, v26, s[24:27], 0 offen
    s_lshl_b32 s68, s2, 2
    s_add_u32 s68, s68, s54
    s_mul_i32 s64, s68, 14
    v_add_u32 v26, s64, v0
    v_lshlrev_b32 v26, 7, v26
    v_mov_b32 v27, 0x40000000
    v_cmp_gt_u32 vcc, 14, v0
    s_nop 1
    v_cndmask_b32 v26, v27, v26, vcc
    buffer_load_dword v163, v26, s[40:43], 0 offen
    s_waitcnt vmcnt(5)
    s_barrier
    v_mov_b32 v26, 0
    buffer_load_dword v30, v26, s[4:7], 0 offen sc1
    v_bfe_u32 v26, v0, 2, 2
    v_and_b32 v27, 3, v0
    v_bfe_u32 v28, v0, 4, 1
    v_lshlrev_b32 v27, 3, v27
    v_lshl_add_u32 v27, v28, 5, v27
    v_lshl_add_u32 v28, v23, 2, v26
    v_lshl_add_u32 v2, v28, 6, v27
    v_lshl_add_u32 v28, v23, 3, v26
    v_lshl_add_u32 v3, v28, 6, v27
    s_barrier
    s_movk_i32 s65, 3584
    v_lshrrev_b32 v26, 2, v0
    v_mul_lo_u32 v26, v26, s65
    v_and_b32 v27, 3, v0
    v_lshl_add_u32 v153, v27, 4, v26
    v_lshrrev_b32 v26, 1, v0
    v_mul_lo_u32 v26, v26, s65
    v_and_b32 v27, 1, v0
    v_lshl_add_u32 v154, v27, 4, v26
    s_mul_i32 s75, s54, 458752
    s_mul_i32 s64, s59, 224
    s_add_u32 s75, s75, s64
    s_and_b32 s65, s59, 1
    s_lshl_b32 s73, s65, 5
    s_add_u32 s73, s73, s75
    s_xor_b32 s65, s65, 1
    s_mul_i32 s65, s65, 192
    s_add_u32 s75, s75, s65
    s_lshl_b32 s72, s54, 13
    s_lshl_b32 s74, s54, 12
    s_barrier
    s_waitcnt vmcnt(0)
    v_readfirstlane_b32 s57, v30
    s_nop 0
    s_mul_i32 s57, s57, 0x9e3779b1
    s_add_u32 s57, s57, 0x7f4a7c15
    v_lshrrev_b32 v26, 3, v0
    v_and_b32 v27, 7, v0
    v_lshlrev_b32 v27, 4, v27
    v_lshl_add_u32 v137, v26, 10, v27
    s_lshl_b32 s64, s52, 6
    s_lshl_b32 s65, s54, 4
    s_add_u32 s64, s64, s65
    v_add_u32 v26, s64, v26
    s_lshl_b32 s93, s64, 10
    s_lshl_b32 s65, s53, 7
    s_add_u32 s93, s93, s65
    v_add_u32 v138, s93, v137
    v_subrev_u32 v138, 3072, v138
    v_mov_b32 v27, 0x40000000
    v_cmp_gt_u32 vcc, 3, v26
    s_nop 1
    v_cndmask_b32 v138, v138, v27, vcc
    s_mul_i32 s94, s54, 5120
    s_add_u32 m0, s94, 139264
    s_nop 0
    buffer_load_dwordx4 v138, s[12:15], 0 offen lds
    s_add_u32 m0, s94, 140288
    s_add_u32 s78, s93, 5120
    buffer_load_dwordx4 v137, s[12:15], s78 offen lds
    s_add_u32 m0, s94, 141312
    s_add_u32 s78, s93, 13312
    buffer_load_dwordx4 v137, s[12:15], s78 offen lds
    s_add_u32 m0, s94, 142336
    s_add_u32 s78, s93, 0
    buffer_load_dwordx4 v137, s[16:19], s78 offen lds
    s_add_u32 m0, s94, 143360
    s_add_u32 s78, s93, 8192
    buffer_load_dwordx4 v137, s[16:19], s78 offen lds
    s_lshl_b32 s65, s53, 9
    v_lshl_add_u32 v26, v24, 4, s65
    buffer_load_dwordx4 v[164:167], v26, s[20:23], 0 offen
    s_add_u32 m0, s70, 0
    s_add_u32 s78, s71, 0
    buffer_load_dwordx4 v31, s[36:39], s78 offen lds
    s_add_u32 m0, s70, 1024
    s_add_u32 s78, s71, 16384
    buffer_load_dwordx4 v31, s[36:39], s78 offen lds
    s_add_u32 m0, s70, 2048
    s_add_u32 s78, s71, 32768
    buffer_load_dwordx4 v31, s[36:39], s78 offen lds
    s_add_u32 m0, s70, 3072
    s_add_u32 s78, s71, 49152
    buffer_load_dwordx4 v31, s[36:39], s78 offen lds
    s_waitcnt vmcnt(4)
    s_mul_i32 s64, s54, 5120
    v_lshlrev_b32 v26, 10, v23
    v_lshl_add_u32 v26, v24, 2, v26
    v_add_u32 v26, s64, v26
    v_add_u32 v26, 139264, v26
    ds_read_b32 v172, v26 offset:0
    ds_read_b32 v173, v26 offset:128
    ds_read_b32 v174, v26 offset:256
    ds_read_b32 v175, v26 offset:384
    ds_read_b32 v176, v26 offset:512
    ds_read_b32 v177, v26 offset:640
    ds_read_b32 v178, v26 offset:768
    ds_read_b32 v179, v26 offset:896
    ds_read_b32 v180, v26 offset:1024
    ds_read_b32 v181, v26 offset:1152
    ds_read_b32 v182, v26 offset:1280
    ds_read_b32 v183, v26 offset:3072
    ds_read_b32 v184, v26 offset:3200
    ds_read_b32 v185, v26 offset:3328
    ds_read_b32 v186, v26 offset:3456
    ds_read_b32 v187, v26 offset:3584
    ds_read_b32 v188, v26 offset:3712
    ds_read_b32 v189, v26 offset:3840
    ds_read_b32 v190, v26 offset:3968
    s_waitcnt lgkmcnt(0)
    v_lshlrev_b32 v94, 16, v164
    v_lshlrev_b32 v95, 16, v166
    v_and_b32 v96, s81, v164
    v_and_b32 v97, s81, v166
    s_add_u32 m0, s70, 4096
    s_add_u32 s78, s71, 65536
    buffer_load_dwordx4 v31, s[36:39], s78 offen lds
    v_lshlrev_b32 v98, 16, v165
    v_lshlrev_b32 v99, 16, v167
    v_and_b32 v100, s81, v165
    v_and_b32 v101, s81, v167
    v_lshlrev_b32 v56, 16, v172
    v_and_b32 v57, s81, v172
    v_lshlrev_b32 v58, 16, v173
    v_and_b32 v59, s81, v173
    v_lshlrev_b32 v60, 16, v174
    v_and_b32 v61, s81, v174
    v_lshlrev_b32 v62, 16, v175
    v_and_b32 v63, s81, v175
    s_add_u32 m0, s70, 5120
    s_add_u32 s78, s71, 81920
    buffer_load_dwordx4 v31, s[36:39], s78 offen lds
    v_lshlrev_b32 v64, 16, v176
    v_and_b32 v65, s81, v176
    v_lshlrev_b32 v66, 16, v177
    v_and_b32 v67, s81, v177
    v_lshlrev_b32 v68, 16, v178
    v_and_b32 v69, s81, v178
    v_lshlrev_b32 v70, 16, v179
    v_and_b32 v71, s81, v179
    v_lshlrev_b32 v72, 16, v180
    v_and_b32 v73, s81, v180
    v_lshlrev_b32 v74, 16, v181
    v_and_b32 v75, s81, v181
    s_add_u32 m0, s70, 6144
    s_add_u32 s78, s71, 98304
    buffer_load_dwordx4 v31, s[36:39], s78 offen lds
    v_lshlrev_b32 v76, 16, v182
    v_and_b32 v77, s81, v182
    v_lshlrev_b32 v78, 16, v183
    v_and_b32 v79, s81, v183
    v_lshlrev_b32 v80, 16, v184
    v_and_b32 v81, s81, v184
    v_lshlrev_b32 v82, 16, v185
    v_and_b32 v83, s81, v185
    v_lshlrev_b32 v84, 16, v186
    v_and_b32 v85, s81, v186
    v_lshlrev_b32 v86, 16, v187
    v_and_b32 v87, s81, v187
    s_add_u32 m0, s70, 7168
    s_add_u32 s78, s71, 114688
    buffer_load_dwordx4 v31, s[36:39], s78 offen lds
    v_lshlrev_b32 v88, 16, v188
    v_and_b32 v89, s81, v188
    v_lshlrev_b32 v90, 16, v189
    v_and_b32 v91, s81, v189
    v_lshlrev_b32 v92, 16, v190
    v_and_b32 v93, s81, v190
    v_pk_mul_f32 v[102:103], v[62:63], v[94:95]
    v_pk_mul_f32 v[104:105], v[64:65], v[94:95]
    v_pk_mul_f32 v[106:107], v[66:67], v[94:95]
    v_pk_mul_f32 v[108:109], v[68:69], v[94:95]
    v_pk_mul_f32 v[110:111], v[70:71], v[94:95]
    v_pk_mul_f32 v[112:113], v[72:73], v[94:95]
    s_add_u32 m0, s70, 8192
    s_add_u32 s78, s71, 131072
    buffer_load_dwordx4 v31, s[36:39], s78 offen lds
    v_pk_mul_f32 v[114:115], v[74:75], v[94:95]
    v_pk_mul_f32 v[116:117], v[76:77], v[94:95]
    v_pk_fma_f32 v[102:103], v[60:61], v[96:97], v[102:103]
    v_pk_fma_f32 v[104:105], v[62:63], v[96:97], v[104:105]
    v_pk_fma_f32 v[106:107], v[64:65], v[96:97], v[106:107]
    v_pk_fma_f32 v[108:109], v[66:67], v[96:97], v[108:109]
    v_pk_fma_f32 v[110:111], v[68:69], v[96:97], v[110:111]
    v_pk_fma_f32 v[112:113], v[70:71], v[96:97], v[112:113]
    v_pk_fma_f32 v[114:115], v[72:73], v[96:97], v[114:115]
    v_pk_fma_f32 v[116:117], v[74:75], v[96:97], v[116:117]
    v_pk_fma_f32 v[102:103], v[58:59], v[98:99], v[102:103]
    v_pk_fma_f32 v[104:105], v[60:61], v[98:99], v[104:105]
    s_add_u32 m0, s70, 9216
    s_add_u32 s78, s71, 147456
    buffer_load_dwordx4 v31, s[36:39], s78 offen lds
    v_pk_fma_f32 v[106:107], v[62:63], v[98:99], v[106:107]
    v_pk_fma_f32 v[108:109], v[64:65], v[98:99], v[108:109]
    v_pk_fma_f32 v[110:111], v[66:67], v[98:99], v[110:111]
    v_pk_fma_f32 v[112:113], v[68:69], v[98:99], v[112:113]
    v_pk_fma_f32 v[114:115], v[70:71], v[98:99], v[114:115]
    v_pk_fma_f32 v[116:117], v[72:73], v[98:99], v[116:117]
    v_pk_fma_f32 v[102:103], v[56:57], v[100:101], v[102:103]
    v_pk_fma_f32 v[104:105], v[58:59], v[100:101], v[104:105]
    v_pk_fma_f32 v[106:107], v[60:61], v[100:101], v[106:107]
    v_pk_fma_f32 v[108:109], v[62:63], v[100:101], v[108:109]
    v_pk_fma_f32 v[110:111], v[64:65], v[100:101], v[110:111]
    v_pk_fma_f32 v[112:113], v[66:67], v[100:101], v[112:113]
    s_add_u32 m0, s70, 10240
    s_add_u32 s78, s71, 163840
    buffer_load_dwordx4 v31, s[36:39], s78 offen lds
    v_pk_fma_f32 v[114:115], v[68:69], v[100:101], v[114:115]
    v_pk_fma_f32 v[116:117], v[70:71], v[100:101], v[116:117]
    v_pk_mul_f32 v[102:103], v[102:103], v[78:79]
    v_pk_mul_f32 v[104:105], v[104:105], v[80:81]
    v_pk_mul_f32 v[106:107], v[106:107], v[82:83]
    v_pk_mul_f32 v[108:109], v[108:109], v[84:85]
    v_pk_mul_f32 v[110:111], v[110:111], v[86:87]
    v_pk_mul_f32 v[112:113], v[112:113], v[88:89]
    v_pk_mul_f32 v[114:115], v[114:115], v[90:91]
    v_pk_mul_f32 v[116:117], v[116:117], v[92:93]
    v_cvt_pk_bf16_f32 v118, v102, v104
    v_cvt_pk_bf16_f32 v119, v106, v108
    s_add_u32 m0, s70, 11264
    s_add_u32 s78, s71, 180224
    buffer_load_dwordx4 v31, s[36:39], s78 offen lds
    v_cvt_pk_bf16_f32 v120, v110, v112
    v_cvt_pk_bf16_f32 v121, v114, v116
    v_cvt_pk_bf16_f32 v122, v103, v105
    v_cvt_pk_bf16_f32 v123, v107, v109
    v_cvt_pk_bf16_f32 v124, v111, v113
    v_cvt_pk_bf16_f32 v125, v115, v117
    s_lshl_b32 s64, s54, 1
    v_add_u32 v26, s64, v23
    v_and_b32 v27, 7, v24
    v_xor_b32 v26, v26, v27
    v_lshlrev_b32 v26, 4, v26
    v_lshl_add_u32 v26, v24, 8, v26
    v_add_u32 v26, 131072, v26
    s_add_u32 m0, s70, 12288
    s_add_u32 s78, s71, 196608
    buffer_load_dwordx4 v31, s[36:39], s78 offen lds
    ds_write_b128 v26, v[118:121]
    ds_write_b128 v26, v[122:125] offset:128
    s_add_u32 m0, s70, 13312
    s_add_u32 s78, s71, 212992
    buffer_load_dwordx4 v31, s[36:39], s78 offen lds
    s_add_u32 m0, s70, 14336
    s_add_u32 s78, s71, 229376
    buffer_load_dwordx4 v31, s[36:39], s78 offen lds
    s_add_u32 m0, s70, 15360
    s_add_u32 s78, s71, 245760
    buffer_load_dwordx4 v31, s[36:39], s78 offen lds
    s_waitcnt lgkmcnt(0)
    s_barrier
    v_lshrrev_b32 v26, 3, v0
    s_lshl_b32 s64, s54, 4
    v_add_u32 v26, s64, v26
    v_and_b32 v27, 7, v0
    v_add_u32 v28, 0, v26
    v_bfe_u32 v29, v28, 1, 3
    v_xor_b32 v29, v29, v27
    v_lshlrev_b32 v29, 4, v29
    v_lshl_add_u32 v29, v28, 7, v29
    v_add_u32 v29, 131072, v29
    ds_read_b128 v[144:147], v29
    v_add_u32 v28, 8, v26
    v_bfe_u32 v29, v28, 1, 3
    v_xor_b32 v29, v29, v27
    v_lshlrev_b32 v29, 4, v29
    v_lshl_add_u32 v29, v28, 7, v29
    v_add_u32 v29, 131072, v29
    ds_read_b128 v[148:151], v29
    v_lshlrev_b32 v27, 4, v27
    v_lshl_add_u32 v152, v26, 12, v27
    s_lshl_b32 s64, s53, 18
    s_lshl_b32 s65, s52, 7
    s_add_u32 s64, s64, s65
    s_add_u32 s64, s64, 0x100000
    s_add_u32 s65, s64, 0x8000
    s_waitcnt lgkmcnt(0)
    buffer_store_dwordx4 v[144:147], v152, s[4:7], s64 offen sc1
    buffer_store_dwordx4 v[148:151], v152, s[4:7], s65 offen sc1
    v_lshlrev_b32 v26, 4, v22
    v_subrev_u32 v27, 8, v26
    v_mov_b32 v28, 0x40000000
    v_cmp_eq_u32 vcc, 0, v22
    s_nop 1
    v_cndmask_b32 v27, v27, v28, vcc
    s_lshl_b32 s64, s2, 13
    buffer_load_dwordx4 v[172:175], v26, s[24:27], s64 offen
    buffer_load_dwordx2 v[176:177], v27, s[24:27], s64 offen
    s_waitcnt vmcnt(4)
    s_barrier
    s_waitcnt vmcnt(2)
    s_lshl_b32 s64, s52, 3
    s_add_u32 s64, s64, s53
    s_lshl_b32 s64, s64, 2
    s_add_u32 s64, s64, s54
    s_lshl_b32 s64, s64, 7
    s_add_u32 s64, s64, 135168
    v_mov_b32 v26, s57
    v_mov_b32 v27, s64
    s_mov_b64 exec, 1
    buffer_store_dword v26, v27, s[4:7], 0 offen sc1
    s_mov_b64 exec, -1
    s_add_u32 m0, s72, 0
    s_add_u32 s78, s73, 0
    buffer_load_dwordx4 v153, s[40:43], s78 offen lds
    s_add_u32 m0, s72, 1024
    s_add_u32 s78, s73, 57344
    buffer_load_dwordx4 v153, s[40:43], s78 offen lds
    s_add_u32 m0, s72, 2048
    s_add_u32 s78, s73, 114688
    buffer_load_dwordx4 v153, s[40:43], s78 offen lds
    s_add_u32 m0, s72, 3072
    s_add_u32 s78, s73, 172032
    buffer_load_dwordx4 v153, s[40:43], s78 offen lds
    s_add_u32 m0, s72, 4096
    s_add_u32 s78, s73, 229376
    buffer_load_dwordx4 v153, s[40:43], s78 offen lds
    s_add_u32 m0, s72, 5120
    s_add_u32 s78, s73, 286720
    buffer_load_dwordx4 v153, s[40:43], s78 offen lds
    s_add_u32 m0, s72, 6144
    s_add_u32 s78, s73, 344064
    buffer_load_dwordx4 v153, s[40:43], s78 offen lds
    s_add_u32 m0, s72, 7168
    s_add_u32 s78, s73, 401408
    buffer_load_dwordx4 v153, s[40:43], s78 offen lds
    s_add_u32 m0, s72, 32768
    s_add_u32 s78, s73, 64
    buffer_load_dwordx4 v153, s[40:43], s78 offen lds
    s_add_u32 m0, s72, 33792
    s_add_u32 s78, s73, 57408
    buffer_load_dwordx4 v153, s[40:43], s78 offen lds
    s_lshr_b32 s64, s2, 5
    s_lshl_b32 s65, s54, 6
    s_add_u32 s64, s64, s65
    v_and_b32 v28, 7, v0
    v_lshlrev_b32 v28, 3, v28
    v_add_u32 v28, s64, v28
    s_bfe_u32 s64, s2, 0x20003
    v_lshl_add_u32 v28, v28, 2, s64
    v_lshlrev_b32 v171, 7, v28
    v_add_u32 v171, 135168, v171
    buffer_load_dword v170, v171, s[4:7], 0 offen sc1
    s_barrier
    s_waitcnt vmcnt(0)
    v_cmp_ne_u32 vcc, s57, v170
    s_nop 0
    s_cmp_eq_u64 vcc, 0
    s_cbranch_scc1 L_polled_100002
    s_mov_b32 s86, 0x40000
L_poll_100001:
    buffer_load_dword v170, v171, s[4:7], 0 offen sc1
    s_waitcnt vmcnt(0)
    v_cmp_ne_u32 vcc, s57, v170
    s_nop 0
    s_cmp_eq_u64 vcc, 0
    s_cbranch_scc1 L_polled_100002
    s_sub_u32 s86, s86, 1
    s_cmp_lg_u32 s86, 0
    s_cbranch_scc1 L_poll_100001
    v_mov_b32 v26, 0
    v_mov_b32 v27, 257
    s_mov_b64 exec, 1
    global_store_dword v26, v27, s[30:31]
    s_mov_b64 exec, -1
L_polled_100002:
    v_lshlrev_b32 v26, 4, v22
    s_lshl_b32 s64, s2, 13
    s_add_u32 s64, s64, 0x100000
    buffer_load_dwordx4 v[178:181], v26, s[4:7], s64 offen sc1
    v_min_u32 v26, 79, v22
    v_subrev_u32 v27, 72, v26
    v_lshrrev_b32 v28, 1, v27
    v_mul_u32_u24 v28, 4128, v28
    v_and_b32 v27, 1, v27
    v_lshl_add_u32 v28, v27, 4, v28
    v_add_u32 v28, 119936, v28
    v_lshlrev_b32 v27, 4, v26
    v_add_u32 v27, 114688, v27
    v_cmp_gt_u32 vcc, 72, v26
    s_nop 1
    v_cndmask_b32 v28, v28, v27, vcc
    v_mov_b32 v32, 0
    v_mov_b32 v33, 0
    v_mov_b32 v34, 0
    v_mov_b32 v35, 0
    ds_write_b128 v28, v[32:35]
    v_alignbit_b32 v36, v177, v176, 16
    v_alignbit_b32 v40, v172, v177, 16
    v_mov_b32 v44, v177
    v_alignbit_b32 v37, v172, v177, 16
    v_alignbit_b32 v41, v173, v172, 16
    v_mov_b32 v45, v172
    v_alignbit_b32 v38, v173, v172, 16
    v_alignbit_b32 v42, v174, v173, 16
    v_mov_b32 v46, v173
    v_alignbit_b32 v39, v174, v173, 16
    v_alignbit_b32 v43, v175, v174, 16
    v_mov_b32 v47, v174
    v_lshlrev_b32 v29, 4, v22
    v_add_u32 v29, 114688, v29
    ds_write_b128 v29, v[172:175] offset:5280
    ds_write_b128 v29, v[40:43] offset:9408
    ds_write_b128 v29, v[44:47] offset:13536
    ds_write_b128 v29, v[36:39] offset:17664
    s_waitcnt lgkmcnt(0)
    s_waitcnt vmcnt(0)
    v_lshlrev_b32 v29, 4, v22
    v_add_u32 v29, 114688, v29
    ds_write_b128 v29, v[178:181] offset:1152
    s_waitcnt lgkmcnt(0)
    s_barrier
    s_lshl_b32 s64, s54, 5
    s_sub_u32 s64, 114816, s64
    v_lshl_add_u32 v26, v0, 3, s64
    ds_read_b64_tr_b16 v[32:33], v26 offset:0
    ds_read_b64_tr_b16 v[34:35], v26 offset:512
    ds_read_b64_tr_b16 v[36:37], v26 offset:1024
    ds_read_b64_tr_b16 v[38:39], v26 offset:1536
    ds_read_b64_tr_b16 v[40:41], v26 offset:2048
    ds_read_b64_tr_b16 v[42:43], v26 offset:2560
    ds_read_b64_tr_b16 v[44:45], v26 offset:3072
    ds_read_b64_tr_b16 v[46:47], v26 offset:3584
    ds_read_b64_tr_b16 v[48:49], v26 offset:4096
    ds_read_b64_tr_b16 v[50:51], v26 offset:4608
    s_mul_i32 s64, s54, 5312
    s_add_u32 s64, s64, 136448
    v_and_b32 v27, 15, v0
    v_mul_u32_u24 v27, 328, v27
    v_lshrrev_b32 v28, 4, v0
    v_lshl_add_u32 v27, v28, 3, v27
    v_add_u32 v27, s64, v27
    s_waitcnt lgkmcnt(9)
    ds_write_b64 v27, v[32:33] offset:0
    s_waitcnt lgkmcnt(9)
    ds_write_b64 v27, v[34:35] offset:32
    s_waitcnt lgkmcnt(9)
    ds_write_b64 v27, v[36:37] offset:64
    s_waitcnt lgkmcnt(9)
    ds_write_b64 v27, v[38:39] offset:96
    s_waitcnt lgkmcnt(9)
    ds_write_b64 v27, v[40:41] offset:128
    s_waitcnt lgkmcnt(9)
    ds_write_b64 v27, v[42:43] offset:160
    s_waitcnt lgkmcnt(9)
    ds_write_b64 v27, v[44:45] offset:192
    s_waitcnt lgkmcnt(9)
    ds_write_b64 v27, v[46:47] offset:224
    s_waitcnt lgkmcnt(9)
    ds_write_b64 v27, v[48:49] offset:256
    s_waitcnt lgkmcnt(9)
    ds_write_b64 v27, v[50:51] offset:288
    s_waitcnt lgkmcnt(0)
    s_add_u32 m0, s72, 34816
    s_add_u32 s78, s73, 114752
    buffer_load_dwordx4 v153, s[40:43], s78 offen lds
    s_add_u32 m0, s72, 35840
    s_add_u32 s78, s73, 172096
    buffer_load_dwordx4 v153, s[40:43], s78 offen lds
    s_add_u32 m0, s72, 36864
    s_add_u32 s78, s73, 229440
    buffer_load_dwordx4 v153, s[40:43], s78 offen lds
    s_add_u32 m0, s72, 37888
    s_add_u32 s78, s73, 286784
    buffer_load_dwordx4 v153, s[40:43], s78 offen lds
    s_add_u32 m0, s72, 38912
    s_add_u32 s78, s73, 344128
    buffer_load_dwordx4 v153, s[40:43], s78 offen lds
    s_add_u32 m0, s72, 39936
    s_add_u32 s78, s73, 401472
    buffer_load_dwordx4 v153, s[40:43], s78 offen lds
    s_barrier
    s_lshr_b32 s68, s2, 3
    s_lshl_b32 s68, s68, 2
    s_add_u32 s68, s68, s54
    s_mul_i32 s69, s68, 14
    v_add_u32 v26, s69, v0
    v_lshlrev_b32 v26, 10, v26
    v_add_u32 v26, 384, v26
    v_mov_b32 v27, 0x40000000
    v_cmp_gt_u32 vcc, 14, v0
    s_nop 1
    v_cndmask_b32 v26, v27, v26, vcc
    buffer_load_dword v161, v26, s[44:47], 0 offen
    s_lshl_b32 s68, s2, 2
    s_add_u32 s68, s68, s54
    s_mul_i32 s64, s68, 14
    v_add_u32 v26, s64, v0
    v_lshlrev_b32 v26, 7, v26
    v_mov_b32 v27, 0x40000000
    v_cmp_gt_u32 vcc, 14, v0
    s_nop 1
    v_cndmask_b32 v26, v27, v26, vcc
    buffer_load_dword v162, v26, s[44:47], 0 offen
    s_add_u32 m0, s72, 65536
    s_add_u32 s78, s73, 128
    buffer_load_dwordx4 v153, s[40:43], s78 offen lds
    s_add_u32 m0, s72, 66560
    s_add_u32 s78, s73, 57472
    buffer_load_dwordx4 v153, s[40:43], s78 offen lds
    s_add_u32 m0, s72, 67584
    s_add_u32 s78, s73, 114816
    buffer_load_dwordx4 v153, s[40:43], s78 offen lds
    s_add_u32 m0, s72, 68608
    s_add_u32 s78, s73, 172160
    buffer_load_dwordx4 v153, s[40:43], s78 offen lds
    s_add_u32 m0, s72, 69632
    s_add_u32 s78, s73, 229504
    buffer_load_dwordx4 v153, s[40:43], s78 offen lds
    s_add_u32 m0, s72, 70656
    s_add_u32 s78, s73, 286848
    buffer_load_dwordx4 v153, s[40:43], s78 offen lds
    s_add_u32 m0, s72, 71680
    s_add_u32 s78, s73, 344192
    buffer_load_dwordx4 v153, s[40:43], s78 offen lds
    s_add_u32 m0, s72, 72704
    s_add_u32 s78, s73, 401536
    buffer_load_dwordx4 v153, s[40:43], s78 offen lds
    s_add_u32 m0, s74, 98304
    s_add_u32 s78, s75, 0
    buffer_load_dwordx4 v154, s[40:43], s78 offen lds
    s_add_u32 m0, s74, 99328
    s_add_u32 s78, s75, 114688
    buffer_load_dwordx4 v154, s[40:43], s78 offen lds
    s_add_u32 m0, s74, 100352
    s_add_u32 s78, s75, 229376
    buffer_load_dwordx4 v154, s[40:43], s78 offen lds
    s_add_u32 m0, s74, 101376
    s_add_u32 s78, s75, 344064
    buffer_load_dwordx4 v154, s[40:43], s78 offen lds
    s_barrier
    s_barrier
    s_waitcnt vmcnt(0)
    s_barrier
    v_add_u32 v144, 0, v2
    v_add_u32 v145, 65536, v2
    v_bfe_u32 v26, v0, 2, 2
    v_lshl_add_u32 v26, v23, 2, v26
    v_and_b32 v27, 3, v0
    v_lshlrev_b32 v27, 3, v27
    v_lshl_add_u32 v26, v26, 5, v27
    v_add_u32 v146, 98304, v26
    v_lshrrev_b32 v26, 4, v0
    v_xor_b32 v26, v26, v0
    v_and_b32 v26, 1, v26
    v_mov_b32 v27, s80
    v_cmp_eq_u32 vcc, 0, v26
    s_nop 1
    v_cndmask_b32 v120, 0, v27, vcc
    v_mov_b32 v121, v120
    v_mov_b32 v122, v120
    v_mov_b32 v123, v120
    s_cmp_lt_u32 s54, 3
    s_cbranch_scc1 L_csfull_100003
    ds_read_b64_tr_b16 v[96:97], v146 offset:0
    ds_read_b64_tr_b16 v[98:99], v146 offset:256
    ds_read_b64_tr_b16 v[100:101], v146 offset:512
    ds_read_b64_tr_b16 v[102:103], v146 offset:768
    ds_read_b64_tr_b16 v[104:105], v146 offset:1024
    ds_read_b64_tr_b16 v[106:107], v146 offset:1280
    ds_read_b64_tr_b16 v[108:109], v146 offset:1536
    ds_read_b64_tr_b16 v[110:111], v146 offset:1792
    ds_read_b64_tr_b16 v[112:113], v146 offset:2048
    ds_read_b64_tr_b16 v[114:115], v146 offset:2304
    s_waitcnt lgkmcnt(8)
    v_mfma_f32_16x16x32_bf16 v[32:35], v[96:99], v[120:123], 0
    ds_read_b64_tr_b16 v[116:117], v146 offset:2560
    ds_read_b64_tr_b16 v[118:119], v146 offset:2816
    s_waitcnt lgkmcnt(8)
    v_mfma_f32_16x16x32_bf16 v[36:39], v[100:103], v[120:123], 0
    ds_read_b64_tr_b16 v[96:97], v146 offset:3072
    ds_read_b64_tr_b16 v[98:99], v146 offset:3328
    s_waitcnt lgkmcnt(8)
    v_mfma_f32_16x16x32_bf16 v[32:35], v[104:107], v[120:123], v[32:35]
    ds_read_b64_tr_b16 v[100:101], v146 offset:3584
    ds_read_b64_tr_b16 v[102:103], v146 offset:3840
    s_waitcnt lgkmcnt(8)
    v_mfma_f32_16x16x32_bf16 v[36:39], v[108:111], v[120:123], v[36:39]
    ds_read_b64_tr_b16 v[104:105], v146 offset:4096
    ds_read_b64_tr_b16 v[106:107], v146 offset:4352
    s_waitcnt lgkmcnt(8)
    v_mfma_f32_16x16x32_bf16 v[32:35], v[112:115], v[120:123], v[32:35]
    ds_read_b64_tr_b16 v[108:109], v146 offset:4608
    ds_read_b64_tr_b16 v[110:111], v146 offset:4864
    s_waitcnt lgkmcnt(8)
    v_mfma_f32_16x16x32_bf16 v[36:39], v[116:119], v[120:123], v[36:39]
    ds_read_b64_tr_b16 v[112:113], v146 offset:5120
    ds_read_b64_tr_b16 v[114:115], v146 offset:5376
    s_waitcnt lgkmcnt(8)
    v_mfma_f32_16x16x32_bf16 v[32:35], v[96:99], v[120:123], v[32:35]
    ds_read_b64_tr_b16 v[116:117], v146 offset:5632
    ds_read_b64_tr_b16 v[118:119], v146 offset:5888
    s_waitcnt lgkmcnt(8)
    v_mfma_f32_16x16x32_bf16 v[36:39], v[100:103], v[120:123], v[36:39]
    ds_read_b64_tr_b16 v[96:97], v146 offset:6144
    ds_read_b64_tr_b16 v[98:99], v146 offset:6400
    s_waitcnt lgkmcnt(8)
    v_mfma_f32_16x16x32_bf16 v[32:35], v[104:107], v[120:123], v[32:35]
    ds_read_b64_tr_b16 v[100:101], v146 offset:6656
    ds_read_b64_tr_b16 v[102:103], v146 offset:6912
    s_waitcnt lgkmcnt(8)
    v_mfma_f32_16x16x32_bf16 v[36:39], v[108:111], v[120:123], v[36:39]
    ds_read_b64_tr_b16 v[104:105], v146 offset:7168
    ds_read_b64_tr_b16 v[106:107], v146 offset:7424
    s_waitcnt lgkmcnt(8)
    v_mfma_f32_16x16x32_bf16 v[32:35], v[112:115], v[120:123], v[32:35]
    ds_read_b64_tr_b16 v[108:109], v146 offset:7680
    ds_read_b64_tr_b16 v[110:111], v146 offset:7936
    s_waitcnt lgkmcnt(8)
    v_mfma_f32_16x16x32_bf16 v[36:39], v[116:119], v[120:123], v[36:39]
    ds_read_b64_tr_b16 v[112:113], v146 offset:8192
    ds_read_b64_tr_b16 v[114:115], v146 offset:8448
    s_waitcnt lgkmcnt(8)
    v_mfma_f32_16x16x32_bf16 v[32:35], v[96:99], v[120:123], v[32:35]
    ds_read_b64_tr_b16 v[116:117], v146 offset:8704
    ds_read_b64_tr_b16 v[118:119], v146 offset:8960
    s_waitcnt lgkmcnt(8)
    v_mfma_f32_16x16x32_bf16 v[36:39], v[100:103], v[120:123], v[36:39]
    ds_read_b64_tr_b16 v[96:97], v146 offset:9216
    ds_read_b64_tr_b16 v[98:99], v146 offset:9472
    s_waitcnt lgkmcnt(8)
    v_mfma_f32_16x16x32_bf16 v[32:35], v[104:107], v[120:123], v[32:35]
    ds_read_b64_tr_b16 v[100:101], v146 offset:9728
    ds_read_b64_tr_b16 v[102:103], v146 offset:9984
    s_waitcnt lgkmcnt(8)
    v_mfma_f32_16x16x32_bf16 v[36:39], v[108:111], v[120:123], v[36:39]
    ds_read_b64_tr_b16 v[104:105], v146 offset:10240
    ds_read_b64_tr_b16 v[106:107], v146 offset:10496
    s_waitcnt lgkmcnt(8)
    v_mfma_f32_16x16x32_bf16 v[32:35], v[112:115], v[120:123], v[32:35]
    ds_read_b64_tr_b16 v[108:109], v146 offset:10752
    ds_read_b64_tr_b16 v[110:111], v146 offset:11008
    s_waitcnt lgkmcnt(8)
    v_mfma_f32_16x16x32_bf16 v[36:39], v[116:119], v[120:123], v[36:39]
    ds_read_b64_tr_b16 v[112:113], v146 offset:11264
    ds_read_b64_tr_b16 v[114:115], v146 offset:11520
    s_waitcnt lgkmcnt(8)
    v_mfma_f32_16x16x32_bf16 v[32:35], v[96:99], v[120:123], v[32:35]
    ds_read_b64_tr_b16 v[116:117], v146 offset:11776
    ds_read_b64_tr_b16 v[118:119], v146 offset:12032
    s_waitcnt lgkmcnt(8)
    v_mfma_f32_16x16x32_bf16 v[36:39], v[100:103], v[120:123], v[36:39]
    ds_read_b64_tr_b16 v[96:97], v146 offset:12288
    ds_read_b64_tr_b16 v[98:99], v146 offset:12544
    s_waitcnt lgkmcnt(8)
    v_mfma_f32_16x16x32_bf16 v[32:35], v[104:107], v[120:123], v[32:35]
    ds_read_b64_tr_b16 v[100:101], v146 offset:12800
    ds_read_b64_tr_b16 v[102:103], v146 offset:13056
    s_waitcnt lgkmcnt(8)
    v_mfma_f32_16x16x32_bf16 v[36:39], v[108:111], v[120:123], v[36:39]
    ds_read_b64_tr_b16 v[104:105], v146 offset:13312
    ds_read_b64_tr_b16 v[106:107], v146 offset:13568
    s_waitcnt lgkmcnt(8)
    v_mfma_f32_16x16x32_bf16 v[32:35], v[112:115], v[120:123], v[32:35]
    ds_read_b64_tr_b16 v[108:109], v146 offset:13824
    ds_read_b64_tr_b16 v[110:111], v146 offset:14080
    s_waitcnt lgkmcnt(8)
    v_mfma_f32_16x16x32_bf16 v[36:39], v[116:119], v[120:123], v[36:39]
    ds_read_b64_tr_b16 v[112:113], v146 offset:14336
    ds_read_b64_tr_b16 v[114:115], v146 offset:14592
    s_waitcnt lgkmcnt(8)
    v_mfma_f32_16x16x32_bf16 v[32:35], v[96:99], v[120:123], v[32:35]
    ds_read_b64_tr_b16 v[116:117], v146 offset:14848
    ds_read_b64_tr_b16 v[118:119], v146 offset:15104
    s_waitcnt lgkmcnt(8)
    v_mfma_f32_16x16x32_bf16 v[36:39], v[100:103], v[120:123], v[36:39]
    ds_read_b64_tr_b16 v[96:97], v146 offset:15360
    ds_read_b64_tr_b16 v[98:99], v146 offset:15616
    s_waitcnt lgkmcnt(8)
    v_mfma_f32_16x16x32_bf16 v[32:35], v[104:107], v[120:123], v[32:35]
    ds_read_b64_tr_b16 v[100:101], v146 offset:15872
    ds_read_b64_tr_b16 v[102:103], v146 offset:16128
    s_waitcnt lgkmcnt(8)
    v_mfma_f32_16x16x32_bf16 v[36:39], v[108:111], v[120:123], v[36:39]
    s_waitcnt lgkmcnt(6)
    v_mfma_f32_16x16x32_bf16 v[32:35], v[112:115], v[120:123], v[32:35]
    s_waitcnt lgkmcnt(4)
    v_mfma_f32_16x16x32_bf16 v[36:39], v[116:119], v[120:123], v[36:39]
    s_waitcnt lgkmcnt(2)
    v_mfma_f32_16x16x32_bf16 v[32:35], v[96:99], v[120:123], v[32:35]
    s_waitcnt lgkmcnt(0)
    v_mfma_f32_16x16x32_bf16 v[36:39], v[100:103], v[120:123], v[36:39]
    s_branch L_csdone_100004
L_csfull_100003:
    s_lshl_b32 s64, s54, 15
    v_add_u32 v148, s64, v144
    ds_read_b64_tr_b16 v[96:97], v148 offset:0
    ds_read_b64_tr_b16 v[98:99], v148 offset:512
    ds_read_b64_tr_b16 v[100:101], v148 offset:1024
    ds_read_b64_tr_b16 v[102:103], v148 offset:1536
    ds_read_b64_tr_b16 v[104:105], v148 offset:2048
    ds_read_b64_tr_b16 v[106:107], v148 offset:2560
    ds_read_b64_tr_b16 v[108:109], v148 offset:3072
    ds_read_b64_tr_b16 v[110:111], v148 offset:3584
    ds_read_b64_tr_b16 v[112:113], v148 offset:4096
    ds_read_b64_tr_b16 v[114:115], v148 offset:4608
    s_waitcnt lgkmcnt(8)
    v_mfma_f32_16x16x32_bf16 v[32:35], v[96:99], v[120:123], 0
    ds_read_b64_tr_b16 v[116:117], v148 offset:5120
    ds_read_b64_tr_b16 v[118:119], v148 offset:5632
    s_waitcnt lgkmcnt(8)
    v_mfma_f32_16x16x32_bf16 v[36:39], v[100:103], v[120:123], 0
    ds_read_b64_tr_b16 v[96:97], v148 offset:6144
    ds_read_b64_tr_b16 v[98:99], v148 offset:6656
    s_waitcnt lgkmcnt(8)
    v_mfma_f32_16x16x32_bf16 v[32:35], v[104:107], v[120:123], v[32:35]
    ds_read_b64_tr_b16 v[100:101], v148 offset:7168
    ds_read_b64_tr_b16 v[102:103], v148 offset:7680
    s_waitcnt lgkmcnt(8)
    v_mfma_f32_16x16x32_bf16 v[36:39], v[108:111], v[120:123], v[36:39]
    ds_read_b64_tr_b16 v[104:105], v148 offset:8192
    ds_read_b64_tr_b16 v[106:107], v148 offset:8704
    s_waitcnt lgkmcnt(8)
    v_mfma_f32_16x16x32_bf16 v[32:35], v[112:115], v[120:123], v[32:35]
    ds_read_b64_tr_b16 v[108:109], v148 offset:9216
    ds_read_b64_tr_b16 v[110:111], v148 offset:9728
    s_waitcnt lgkmcnt(8)
    v_mfma_f32_16x16x32_bf16 v[36:39], v[116:119], v[120:123], v[36:39]
    ds_read_b64_tr_b16 v[112:113], v148 offset:10240
    ds_read_b64_tr_b16 v[114:115], v148 offset:10752
    s_waitcnt lgkmcnt(8)
    v_mfma_f32_16x16x32_bf16 v[32:35], v[96:99], v[120:123], v[32:35]
    ds_read_b64_tr_b16 v[116:117], v148 offset:11264
    ds_read_b64_tr_b16 v[118:119], v148 offset:11776
    s_waitcnt lgkmcnt(8)
    v_mfma_f32_16x16x32_bf16 v[36:39], v[100:103], v[120:123], v[36:39]
    ds_read_b64_tr_b16 v[96:97], v148 offset:12288
    ds_read_b64_tr_b16 v[98:99], v148 offset:12800
    s_waitcnt lgkmcnt(8)
    v_mfma_f32_16x16x32_bf16 v[32:35], v[104:107], v[120:123], v[32:35]
    ds_read_b64_tr_b16 v[100:101], v148 offset:13312
    ds_read_b64_tr_b16 v[102:103], v148 offset:13824
    s_waitcnt lgkmcnt(8)
    v_mfma_f32_16x16x32_bf16 v[36:39], v[108:111], v[120:123], v[36:39]
    ds_read_b64_tr_b16 v[104:105], v148 offset:14336
    ds_read_b64_tr_b16 v[106:107], v148 offset:14848
    s_waitcnt lgkmcnt(8)
    v_mfma_f32_16x16x32_bf16 v[32:35], v[112:115], v[120:123], v[32:35]
    ds_read_b64_tr_b16 v[108:109], v148 offset:15360
    ds_read_b64_tr_b16 v[110:111], v148 offset:15872
    s_waitcnt lgkmcnt(8)
    v_mfma_f32_16x16x32_bf16 v[36:39], v[116:119], v[120:123], v[36:39]
    ds_read_b64_tr_b16 v[112:113], v148 offset:16384
    ds_read_b64_tr_b16 v[114:115], v148 offset:16896
    s_waitcnt lgkmcnt(8)
    v_mfma_f32_16x16x32_bf16 v[32:35], v[96:99], v[120:123], v[32:35]
    ds_read_b64_tr_b16 v[116:117], v148 offset:17408
    ds_read_b64_tr_b16 v[118:119], v148 offset:17920
    s_waitcnt lgkmcnt(8)
    v_mfma_f32_16x16x32_bf16 v[36:39], v[100:103], v[120:123], v[36:39]
    ds_read_b64_tr_b16 v[96:97], v148 offset:18432
    ds_read_b64_tr_b16 v[98:99], v148 offset:18944
    s_waitcnt lgkmcnt(8)
    v_mfma_f32_16x16x32_bf16 v[32:35], v[104:107], v[120:123], v[32:35]
    ds_read_b64_tr_b16 v[100:101], v148 offset:19456
    ds_read_b64_tr_b16 v[102:103], v148 offset:19968
    s_waitcnt lgkmcnt(8)
    v_mfma_f32_16x16x32_bf16 v[36:39], v[108:111], v[120:123], v[36:39]
    ds_read_b64_tr_b16 v[104:105], v148 offset:20480
    ds_read_b64_tr_b16 v[106:107], v148 offset:20992
    s_waitcnt lgkmcnt(8)
    v_mfma_f32_16x16x32_bf16 v[32:35], v[112:115], v[120:123], v[32:35]
    ds_read_b64_tr_b16 v[108:109], v148 offset:21504
    ds_read_b64_tr_b16 v[110:111], v148 offset:22016
    s_waitcnt lgkmcnt(8)
    v_mfma_f32_16x16x32_bf16 v[36:39], v[116:119], v[120:123], v[36:39]
    ds_read_b64_tr_b16 v[112:113], v148 offset:22528
    ds_read_b64_tr_b16 v[114:115], v148 offset:23040
    s_waitcnt lgkmcnt(8)
    v_mfma_f32_16x16x32_bf16 v[32:35], v[96:99], v[120:123], v[32:35]
    ds_read_b64_tr_b16 v[116:117], v148 offset:23552
    ds_read_b64_tr_b16 v[118:119], v148 offset:24064
    s_waitcnt lgkmcnt(8)
    v_mfma_f32_16x16x32_bf16 v[36:39], v[100:103], v[120:123], v[36:39]
    ds_read_b64_tr_b16 v[96:97], v148 offset:24576
    ds_read_b64_tr_b16 v[98:99], v148 offset:25088
    s_waitcnt lgkmcnt(8)
    v_mfma_f32_16x16x32_bf16 v[32:35], v[104:107], v[120:123], v[32:35]
    ds_read_b64_tr_b16 v[100:101], v148 offset:25600
    ds_read_b64_tr_b16 v[102:103], v148 offset:26112
    s_waitcnt lgkmcnt(8)
    v_mfma_f32_16x16x32_bf16 v[36:39], v[108:111], v[120:123], v[36:39]
    ds_read_b64_tr_b16 v[104:105], v148 offset:26624
    ds_read_b64_tr_b16 v[106:107], v148 offset:27136
    s_waitcnt lgkmcnt(8)
    v_mfma_f32_16x16x32_bf16 v[32:35], v[112:115], v[120:123], v[32:35]
    ds_read_b64_tr_b16 v[108:109], v148 offset:27648
    ds_read_b64_tr_b16 v[110:111], v148 offset:28160
    s_waitcnt lgkmcnt(8)
    v_mfma_f32_16x16x32_bf16 v[36:39], v[116:119], v[120:123], v[36:39]
    ds_read_b64_tr_b16 v[112:113], v148 offset:28672
    ds_read_b64_tr_b16 v[114:115], v148 offset:29184
    s_waitcnt lgkmcnt(8)
    v_mfma_f32_16x16x32_bf16 v[32:35], v[96:99], v[120:123], v[32:35]
    ds_read_b64_tr_b16 v[116:117], v148 offset:29696
    ds_read_b64_tr_b16 v[118:119], v148 offset:30208
    s_waitcnt lgkmcnt(8)
    v_mfma_f32_16x16x32_bf16 v[36:39], v[100:103], v[120:123], v[36:39]
    ds_read_b64_tr_b16 v[96:97], v148 offset:30720
    ds_read_b64_tr_b16 v[98:99], v148 offset:31232
    s_waitcnt lgkmcnt(8)
    v_mfma_f32_16x16x32_bf16 v[32:35], v[104:107], v[120:123], v[32:35]
    ds_read_b64_tr_b16 v[100:101], v148 offset:31744
    ds_read_b64_tr_b16 v[102:103], v148 offset:32256
    s_waitcnt lgkmcnt(8)
    v_mfma_f32_16x16x32_bf16 v[36:39], v[108:111], v[120:123], v[36:39]
    s_waitcnt lgkmcnt(6)
    v_mfma_f32_16x16x32_bf16 v[32:35], v[112:115], v[120:123], v[32:35]
    s_waitcnt lgkmcnt(4)
    v_mfma_f32_16x16x32_bf16 v[36:39], v[116:119], v[120:123], v[36:39]
    s_waitcnt lgkmcnt(2)
    v_mfma_f32_16x16x32_bf16 v[32:35], v[96:99], v[120:123], v[32:35]
    s_waitcnt lgkmcnt(0)
    v_mfma_f32_16x16x32_bf16 v[36:39], v[100:103], v[120:123], v[36:39]
L_csdone_100004:
    s_nop 7
    v_pk_add_f32 v[32:33], v[32:33], v[36:37]
    v_pk_add_f32 v[34:35], v[34:35], v[38:39]
    s_lshl_b32 s64, s54, 7
    s_add_u32 s64, s64, 161280
    v_and_b32 v28, 1, v0
    v_lshlrev_b32 v28, 6, v28
    v_lshrrev_b32 v29, 4, v0
    v_lshl_add_u32 v28, v29, 4, v28
    v_add_u32 v28, s64, v28
    s_mov_b32 exec_lo, 0x30003
    s_mov_b32 exec_hi, 0x30003
    ds_write_b128 v28, v[32:35]
    s_mov_b64 exec, -1
    s_waitcnt lgkmcnt(0)
    s_lshl_b32 s76, s56, 11
    s_lshl_b32 s64, s55, 10
    s_add_u32 s76, s76, s64
    s_mul_i32 s77, s56, 917504
    s_lshl_b32 s64, s53, 7
    s_lshl_b32 s78, s55, 6
    s_add_u32 s64, s64, s78
    s_add_u32 s77, s77, s64
    s_add_u32 s12, s77, 0
    s_add_u32 s13, s77, 114688
    s_add_u32 s14, s77, 229376
    s_add_u32 s15, s77, 344064
    s_add_u32 s16, s77, 458752
    s_add_u32 s17, s77, 573440
    s_add_u32 s18, s77, 688128
    s_add_u32 s19, s77, 802816
    s_barrier
    v_lshlrev_b32 v26, 4, v22
    v_subrev_u32 v27, 8, v26
    v_mov_b32 v28, 0x40000000
    v_cmp_eq_u32 vcc, 0, v22
    s_nop 1
    v_cndmask_b32 v27, v27, v28, vcc
    s_lshl_b32 s64, s2, 13
    s_add_u32 s64, s64, 0x1000
    buffer_load_dwordx4 v[172:175], v26, s[24:27], s64 offen
    buffer_load_dwordx2 v[176:177], v27, s[24:27], s64 offen
    v_lshlrev_b32 v26, 4, v22
    s_lshl_b32 s64, s2, 13
    s_add_u32 s64, s64, 0x101000
    buffer_load_dwordx4 v[178:181], v26, s[4:7], s64 offen sc1
    s_add_u32 m0, s76, 114688
    s_add_u32 s78, s12, 0
    buffer_load_dwordx4 v31, s[44:47], s78 offen lds
    s_add_u32 m0, s76, 118784
    s_add_u32 s78, s12, 16384
    buffer_load_dwordx4 v31, s[44:47], s78 offen lds
    s_add_u32 m0, s76, 122880
    s_add_u32 s78, s12, 32768
    buffer_load_dwordx4 v31, s[44:47], s78 offen lds
    s_add_u32 m0, s76, 126976
    s_add_u32 s78, s12, 49152
    buffer_load_dwordx4 v31, s[44:47], s78 offen lds
    s_add_u32 m0, s76, 131072
    s_add_u32 s78, s12, 65536
    buffer_load_dwordx4 v31, s[44:47], s78 offen lds
    s_add_u32 m0, s76, 135168
    s_add_u32 s78, s12, 81920
    buffer_load_dwordx4 v31, s[44:47], s78 offen lds
    s_add_u32 m0, s76, 139264
    s_add_u32 s78, s12, 98304
    buffer_load_dwordx4 v31, s[44:47], s78 offen lds
    s_add_u32 m0, s76, 143360
    s_add_u32 s78, s13, 0
    buffer_load_dwordx4 v31, s[44:47], s78 offen lds
    s_add_u32 m0, s76, 147456
    s_add_u32 s78, s13, 16384
    buffer_load_dwordx4 v31, s[44:47], s78 offen lds
    s_add_u32 m0, s76, 151552
    s_add_u32 s78, s13, 32768
    buffer_load_dwordx4 v31, s[44:47], s78 offen lds
    s_add_u32 m0, s76, 155648
    s_add_u32 s78, s13, 49152
    buffer_load_dwordx4 v31, s[44:47], s78 offen lds
    s_add_u32 s78, s16, 0
    buffer_load_dwordx4 v[56:59], v31, s[44:47], s78 offen
    s_add_u32 s78, s16, 16384
    buffer_load_dwordx4 v[60:63], v31, s[44:47], s78 offen
    s_add_u32 s78, s16, 32768
    buffer_load_dwordx4 v[64:67], v31, s[44:47], s78 offen
    s_add_u32 s78, s16, 49152
    buffer_load_dwordx4 v[68:71], v31, s[44:47], s78 offen
    s_add_u32 s78, s16, 65536
    buffer_load_dwordx4 v[72:75], v31, s[44:47], s78 offen
    s_add_u32 s78, s16, 81920
    buffer_load_dwordx4 v[76:79], v31, s[44:47], s78 offen
    s_add_u32 s78, s16, 98304
    buffer_load_dwordx4 v[80:83], v31, s[44:47], s78 offen
    s_add_u32 s78, s17, 0
    buffer_load_dwordx4 v[84:87], v31, s[44:47], s78 offen
    s_barrier
    s_waitcnt vmcnt(20)
    v_min_u32 v26, 79, v22
    v_subrev_u32 v27, 72, v26
    v_lshrrev_b32 v28, 1, v27
    v_mul_u32_u24 v28, 4128, v28
    v_and_b32 v27, 1, v27
    v_lshl_add_u32 v28, v27, 4, v28
    v_add_u32 v28, 74880, v28
    v_lshlrev_b32 v27, 4, v26
    v_add_u32 v27, 69632, v27
    v_cmp_gt_u32 vcc, 72, v26
    s_nop 1
    v_cndmask_b32 v28, v28, v27, vcc
    v_mov_b32 v32, 0
    v_mov_b32 v33, 0
    v_mov_b32 v34, 0
    v_mov_b32 v35, 0
    ds_write_b128 v28, v[32:35]
    v_alignbit_b32 v36, v177, v176, 16
    v_alignbit_b32 v40, v172, v177, 16
    v_mov_b32 v44, v177
    v_alignbit_b32 v37, v172, v177, 16
    v_alignbit_b32 v41, v173, v172, 16
    v_mov_b32 v45, v172
    v_alignbit_b32 v38, v173, v172, 16
    v_alignbit_b32 v42, v174, v173, 16
    v_mov_b32 v46, v173
    v_alignbit_b32 v39, v174, v173, 16
    v_alignbit_b32 v43, v175, v174, 16
    v_mov_b32 v47, v174
    v_lshlrev_b32 v29, 4, v22
    v_add_u32 v29, 69632, v29
    ds_write_b128 v29, v[172:175] offset:5280
    ds_write_b128 v29, v[40:43] offset:9408
    ds_write_b128 v29, v[44:47] offset:13536
    ds_write_b128 v29, v[36:39] offset:17664
    s_waitcnt lgkmcnt(0)
    s_waitcnt vmcnt(19)
    v_lshlrev_b32 v29, 4, v22
    v_add_u32 v29, 69632, v29
    ds_write_b128 v29, v[178:181] offset:1152
    s_waitcnt lgkmcnt(0)
    s_barrier
    s_lshl_b32 s64, s54, 5
    s_sub_u32 s64, 69760, s64
    v_lshl_add_u32 v26, v0, 3, s64
    ds_read_b64_tr_b16 v[32:33], v26 offset:0
    ds_read_b64_tr_b16 v[34:35], v26 offset:512
    ds_read_b64_tr_b16 v[36:37], v26 offset:1024
    ds_read_b64_tr_b16 v[38:39], v26 offset:1536
    ds_read_b64_tr_b16 v[40:41], v26 offset:2048
    ds_read_b64_tr_b16 v[42:43], v26 offset:2560
    ds_read_b64_tr_b16 v[44:45], v26 offset:3072
    ds_read_b64_tr_b16 v[46:47], v26 offset:3584
    ds_read_b64_tr_b16 v[48:49], v26 offset:4096
    ds_read_b64_tr_b16 v[50:51], v26 offset:4608
    s_mul_i32 s64, s54, 5312
    s_add_u32 s64, s64, 91392
    v_and_b32 v27, 15, v0
    v_mul_u32_u24 v27, 328, v27
    v_lshrrev_b32 v28, 4, v0
    v_lshl_add_u32 v27, v28, 3, v27
    v_add_u32 v27, s64, v27
    s_waitcnt lgkmcnt(9)
    ds_write_b64 v27, v[32:33] offset:0
    s_waitcnt lgkmcnt(9)
    ds_write_b64 v27, v[34:35] offset:32
    s_waitcnt lgkmcnt(9)
    ds_write_b64 v27, v[36:37] offset:64
    s_waitcnt lgkmcnt(9)
    ds_write_b64 v27, v[38:39] offset:96
    s_waitcnt lgkmcnt(9)
    ds_write_b64 v27, v[40:41] offset:128
    s_waitcnt lgkmcnt(9)
    ds_write_b64 v27, v[42:43] offset:160
    s_waitcnt lgkmcnt(9)
    ds_write_b64 v27, v[44:45] offset:192
    s_waitcnt lgkmcnt(9)
    ds_write_b64 v27, v[46:47] offset:224
    s_waitcnt lgkmcnt(9)
    ds_write_b64 v27, v[48:49] offset:256
    s_waitcnt lgkmcnt(9)
    ds_write_b64 v27, v[50:51] offset:288
    s_waitcnt lgkmcnt(0)
    s_add_u32 s78, s17, 16384
    buffer_load_dwordx4 v[88:91], v31, s[44:47], s78 offen
    s_add_u32 s78, s17, 32768
    buffer_load_dwordx4 v[92:95], v31, s[44:47], s78 offen
    s_add_u32 s78, s17, 49152
    buffer_load_dwordx4 v[96:99], v31, s[44:47], s78 offen
    s_add_u32 s78, s17, 65536
    buffer_load_dwordx4 v[100:103], v31, s[44:47], s78 offen
    s_add_u32 s78, s17, 81920
    buffer_load_dwordx4 v[104:107], v31, s[44:47], s78 offen
    s_add_u32 s78, s17, 98304
    buffer_load_dwordx4 v[108:111], v31, s[44:47], s78 offen
    s_add_u32 s78, s18, 0
    buffer_load_dwordx4 v[112:115], v31, s[44:47], s78 offen
    s_add_u32 s78, s18, 16384
    buffer_load_dwordx4 v[116:119], v31, s[44:47], s78 offen
    s_add_u32 s78, s18, 32768
    buffer_load_dwordx4 v[120:123], v31, s[44:47], s78 offen
    s_add_u32 s78, s18, 49152
    buffer_load_dwordx4 v[124:127], v31, s[44:47], s78 offen
    s_add_u32 s78, s18, 65536
    buffer_load_dwordx4 v[128:131], v31, s[44:47], s78 offen
    s_add_u32 s78, s18, 81920
    buffer_load_dwordx4 v[132:135], v31, s[44:47], s78 offen
    s_add_u32 m0, s76, 0
    s_add_u32 s78, s13, 65536
    buffer_load_dwordx4 v31, s[44:47], s78 offen lds
    s_add_u32 m0, s76, 4096
    s_add_u32 s78, s13, 81920
    buffer_load_dwordx4 v31, s[44:47], s78 offen lds
    s_add_u32 m0, s76, 8192
    s_add_u32 s78, s13, 98304
    buffer_load_dwordx4 v31, s[44:47], s78 offen lds
    s_add_u32 m0, s76, 12288
    s_add_u32 s78, s14, 0
    buffer_load_dwordx4 v31, s[44:47], s78 offen lds
    s_barrier
    s_add_u32 m0, s76, 16384
    s_add_u32 s78, s14, 16384
    buffer_load_dwordx4 v31, s[44:47], s78 offen lds
    s_add_u32 m0, s76, 20480
    s_add_u32 s78, s14, 32768
    buffer_load_dwordx4 v31, s[44:47], s78 offen lds
    s_add_u32 m0, s76, 24576
    s_add_u32 s78, s14, 49152
    buffer_load_dwordx4 v31, s[44:47], s78 offen lds
    s_add_u32 m0, s76, 28672
    s_add_u32 s78, s14, 65536
    buffer_load_dwordx4 v31, s[44:47], s78 offen lds
    s_add_u32 m0, s76, 32768
    s_add_u32 s78, s14, 81920
    buffer_load_dwordx4 v31, s[44:47], s78 offen lds
    s_add_u32 m0, s76, 36864
    s_add_u32 s78, s14, 98304
    buffer_load_dwordx4 v31, s[44:47], s78 offen lds
    s_add_u32 m0, s76, 40960
    s_add_u32 s78, s15, 0
    buffer_load_dwordx4 v31, s[44:47], s78 offen lds
    s_add_u32 m0, s76, 45056
    s_add_u32 s78, s15, 16384
    buffer_load_dwordx4 v31, s[44:47], s78 offen lds
    s_add_u32 m0, s76, 49152
    s_add_u32 s78, s15, 32768
    buffer_load_dwordx4 v31, s[44:47], s78 offen lds
    s_add_u32 m0, s76, 53248
    s_add_u32 s78, s15, 49152
    buffer_load_dwordx4 v31, s[44:47], s78 offen lds
    s_add_u32 m0, s76, 57344
    s_add_u32 s78, s15, 65536
    buffer_load_dwordx4 v31, s[44:47], s78 offen lds
    s_add_u32 m0, s76, 61440
    s_add_u32 s78, s15, 81920
    buffer_load_dwordx4 v31, s[44:47], s78 offen lds
    s_add_u32 m0, s76, 65536
    s_add_u32 s78, s15, 98304
    buffer_load_dwordx4 v31, s[44:47], s78 offen lds
    s_add_u32 s78, s18, 98304
    buffer_load_dwordx4 v[136:139], v31, s[44:47], s78 offen
    s_add_u32 s78, s19, 0
    buffer_load_dwordx4 v[140:143], v31, s[44:47], s78 offen
    s_add_u32 s78, s19, 16384
    buffer_load_dwordx4 v[144:147], v31, s[44:47], s78 offen
    s_add_u32 s78, s19, 32768
    buffer_load_dwordx4 v[148:151], v31, s[44:47], s78 offen
    s_add_u32 s78, s19, 49152
    buffer_load_dwordx4 v[152:155], v31, s[44:47], s78 offen
    s_add_u32 s78, s19, 65536
    buffer_load_dwordx4 v[156:159], v31, s[44:47], s78 offen
    s_add_u32 s78, s19, 81920
    buffer_load_dwordx4 v[160:163], v31, s[44:47], s78 offen
    s_add_u32 s78, s19, 98304
    buffer_load_dwordx4 v[164:167], v31, s[44:47], s78 offen
    s_barrier
    s_barrier
    s_waitcnt vmcnt(8)
    s_barrier
    s_waitcnt vmcnt(0)
    v_add_u32 v28, s76, v1
    v_add_u32 v29, s76, v1
    v_add_u32 v29, 65536, v29
    v_add_u32 v30, s76, v1
    v_add_u32 v30, 131072, v30
    ds_write_b128 v29, v[56:59] offset:4096
    ds_write_b128 v29, v[60:63] offset:8192
    ds_write_b128 v29, v[64:67] offset:12288
    ds_write_b128 v29, v[68:71] offset:16384
    ds_write_b128 v29, v[72:75] offset:20480
    ds_write_b128 v29, v[76:79] offset:24576
    ds_write_b128 v29, v[80:83] offset:28672
    ds_write_b128 v29, v[84:87] offset:32768
    ds_write_b128 v29, v[88:91] offset:36864
    ds_write_b128 v29, v[92:95] offset:40960
    ds_write_b128 v29, v[96:99] offset:45056
    s_waitcnt lgkmcnt(0)
    s_barrier
    v_add_u32 v28, s76, v1
    v_add_u32 v29, s76, v1
    v_add_u32 v29, 65536, v29
    v_add_u32 v30, s76, v1
    v_add_u32 v30, 131072, v30
    ds_write_b128 v29, v[100:103] offset:49152
    ds_write_b128 v29, v[104:107] offset:53248
    ds_write_b128 v29, v[108:111] offset:57344
    ds_write_b128 v29, v[112:115] offset:61440
    ds_write_b128 v30, v[116:119] offset:0
    ds_write_b128 v30, v[120:123] offset:4096
    ds_write_b128 v30, v[124:127] offset:8192
    ds_write_b128 v30, v[128:131] offset:12288
    ds_write_b128 v30, v[132:135] offset:16384
    ds_write_b128 v30, v[136:139] offset:20480
    ds_write_b128 v30, v[140:143] offset:24576
    ds_write_b128 v28, v[144:147] offset:0
    ds_write_b128 v28, v[148:151] offset:4096
    ds_write_b128 v28, v[152:155] offset:8192
    ds_write_b128 v28, v[156:159] offset:12288
    ds_write_b128 v28, v[160:163] offset:16384
    ds_write_b128 v28, v[164:167] offset:20480
    s_waitcnt lgkmcnt(0)
    s_barrier
    s_cmp_lg_u32 s2, 0
    s_cbranch_scc1 L_nonce_100005
    s_cmp_lg_u32 s54, 0
    s_cbranch_scc1 L_nonce_100005
    v_add_u32 v28, 0, v0
    v_lshlrev_b32 v28, 2, v28
    v_lshlrev_b32 v171, 7, v28
    v_add_u32 v171, 135168, v171
    buffer_load_dword v170, v171, s[4:7], 0 offen sc1
    s_waitcnt vmcnt(0)
    v_cmp_ne_u32 vcc, s57, v170
    s_nop 0
    s_cmp_eq_u64 vcc, 0
    s_cbranch_scc1 L_polled_100007
    s_mov_b32 s86, 0x40000
L_poll_100006:
    buffer_load_dword v170, v171, s[4:7], 0 offen sc1
    s_waitcnt vmcnt(0)
    v_cmp_ne_u32 vcc, s57, v170
    s_nop 0
    s_cmp_eq_u64 vcc, 0
    s_cbranch_scc1 L_polled_100007
    s_sub_u32 s86, s86, 1
    s_cmp_lg_u32 s86, 0
    s_cbranch_scc1 L_poll_100006
    v_mov_b32 v26, 0
    v_mov_b32 v27, 262
    s_mov_b64 exec, 1
    global_store_dword v26, v27, s[30:31]
    s_mov_b64 exec, -1
L_polled_100007:
    v_add_u32 v28, 64, v0
    v_lshlrev_b32 v28, 2, v28
    v_lshlrev_b32 v171, 7, v28
    v_add_u32 v171, 135168, v171
    buffer_load_dword v170, v171, s[4:7], 0 offen sc1
    s_waitcnt vmcnt(0)
    v_cmp_ne_u32 vcc, s57, v170
    s_nop 0
    s_cmp_eq_u64 vcc, 0
    s_cbranch_scc1 L_polled_100009
    s_mov_b32 s86, 0x40000
L_poll_100008:
    buffer_load_dword v170, v171, s[4:7], 0 offen sc1
    s_waitcnt vmcnt(0)
    v_cmp_ne_u32 vcc, s57, v170
    s_nop 0
    s_cmp_eq_u64 vcc, 0
    s_cbranch_scc1 L_polled_100009
    s_sub_u32 s86, s86, 1
    s_cmp_lg_u32 s86, 0
    s_cbranch_scc1 L_poll_100008
    v_mov_b32 v26, 0
    v_mov_b32 v27, 262
    s_mov_b64 exec, 1
    global_store_dword v26, v27, s[30:31]
    s_mov_b64 exec, -1
L_polled_100009:
    v_add_u32 v28, 128, v0
    v_lshlrev_b32 v28, 2, v28
    v_lshlrev_b32 v171, 7, v28
    v_add_u32 v171, 135168, v171
    buffer_load_dword v170, v171, s[4:7], 0 offen sc1
    s_waitcnt vmcnt(0)
    v_cmp_ne_u32 vcc, s57, v170
    s_nop 0
    s_cmp_eq_u64 vcc, 0
    s_cbranch_scc1 L_polled_100011
    s_mov_b32 s86, 0x40000
L_poll_100010:
    buffer_load_dword v170, v171, s[4:7], 0 offen sc1
    s_waitcnt vmcnt(0)
    v_cmp_ne_u32 vcc, s57, v170
    s_nop 0
    s_cmp_eq_u64 vcc, 0
    s_cbranch_scc1 L_polled_100011
    s_sub_u32 s86, s86, 1
    s_cmp_lg_u32 s86, 0
    s_cbranch_scc1 L_poll_100010
    v_mov_b32 v26, 0
    v_mov_b32 v27, 262
    s_mov_b64 exec, 1
    global_store_dword v26, v27, s[30:31]
    s_mov_b64 exec, -1
L_polled_100011:
    v_add_u32 v28, 192, v0
    v_lshlrev_b32 v28, 2, v28
    v_lshlrev_b32 v171, 7, v28
    v_add_u32 v171, 135168, v171
    buffer_load_dword v170, v171, s[4:7], 0 offen sc1
    s_waitcnt vmcnt(0)
    v_cmp_ne_u32 vcc, s57, v170
    s_nop 0
    s_cmp_eq_u64 vcc, 0
    s_cbranch_scc1 L_polled_100013
    s_mov_b32 s86, 0x40000
L_poll_100012:
    buffer_load_dword v170, v171, s[4:7], 0 offen sc1
    s_waitcnt vmcnt(0)
    v_cmp_ne_u32 vcc, s57, v170
    s_nop 0
    s_cmp_eq_u64 vcc, 0
    s_cbranch_scc1 L_polled_100013
    s_sub_u32 s86, s86, 1
    s_cmp_lg_u32 s86, 0
    s_cbranch_scc1 L_poll_100012
    v_mov_b32 v26, 0
    v_mov_b32 v27, 262
    s_mov_b64 exec, 1
    global_store_dword v26, v27, s[30:31]
    s_mov_b64 exec, -1
L_polled_100013:
    v_mov_b32 v26, 0
    v_mov_b32 v27, s57
    s_mov_b64 exec, 1
    buffer_store_dword v27, v26, s[4:7], 0 offen sc1
    s_mov_b64 exec, -1
L_nonce_100005:
    s_endpgm
L_codeend:
    s_endpgm
.section .rodata,"a"
.p2align 6
.amdhsa_kernel parallel_sum__ssm_conv_h3__mixer_s_mlp__prompt_kernel
  .amdhsa_next_free_vgpr 256
  .amdhsa_next_free_sgpr 102
  .amdhsa_accum_offset 192
  .amdhsa_group_segment_fixed_size 0
  .amdhsa_kernarg_size 112
  .amdhsa_user_sgpr_count 2
  .amdhsa_user_sgpr_kernarg_segment_ptr 1
  .amdhsa_system_sgpr_workgroup_id_x 1
  .amdhsa_float_denorm_mode_32 3
.end_amdhsa_kernel
```
